```python
import torch

def _softmax(x, axis=-1):
    return torch.softmax(x, dim=axis)
def _gelu(x):
    return torch.nn.functional.gelu(x, approximate="tanh")
def _silu(x):
    return torch.nn.functional.silu(x)
def _sigmoid(x):
    return torch.sigmoid(x)
def _layernorm(x, axis=-1, eps=1e-5):
    m = x.mean(dim=axis, keepdim=True)
    v = x.var(dim=axis, keepdim=True, unbiased=False)
    return (x - m) / torch.sqrt(v + eps)
def _scatter_add(tgt, idx, src, axis=0):
    return tgt.clone().index_add_(axis, idx, src)
def _segment_sum(src, seg, n):
    out = torch.zeros((n,) + src.shape[1:], dtype=src.dtype)
    return out.index_add_(0, seg, src)
def _pad(x, pw):
    flat = tuple(v for pair in reversed(pw) for v in pair)
    return torch.nn.functional.pad(x, flat)

kernel_name = 'standalone__mha_block__prompt'

def setup_inputs():

    _w = (lambda a: (lambda t: t.to(torch.bfloat16) if t.is_floating_point() else t)(torch.as_tensor(a)))
    B, S, D, H = 1, 2048, 576, 32
    return {
        "x": _w((lambda *s: torch.randn(*s, dtype=torch.bfloat16) * 0.2)(B, S, D)),
        "wqkv": _w((lambda *s: torch.randn(*s, dtype=torch.bfloat16) * 0.2)(D, 3 * D)),
        "wo": _w((lambda *s: torch.randn(*s, dtype=torch.bfloat16) * 0.05)(D, D)),
    }

def reference(x, wqkv, wo):
    B, S, D = x.shape
    H = 32
    Dh = D // H
    qkv = (lambda x, *d: x.permute(*d))((x @ wqkv).reshape(B, S, 3, H, Dh), 2, 0, 3, 1, 4)
    q, k, v = qkv[0], qkv[1], qkv[2]
    scores = torch.einsum("bhqd,bhkd->bhqk", q, k) * (Dh ** -0.5)
    p = _softmax(scores, axis=-1)
    o = torch.einsum("bhqk,bhkd->bhqd", p, v)
    return (lambda x, *d: x.permute(*d))(o, 0, 2, 1, 3).reshape(B, S, D) @ wo
```

```asm
; @launch grid=(256,1,1) block=(512,1,1) lds=163840
.amdgcn_target "amdgcn-amd-amdhsa--gfx950"
.text
.globl standalone__mha_block__prompt_kernel
.p2align 12
.p2align 8
.type standalone__mha_block__prompt_kernel,@function
standalone__mha_block__prompt_kernel:
    s_cmp_ge_u32 s2, 256
    s_cbranch_scc1 L_exit
    s_load_dwordx4 s[44:47], s[0:1], 0
    v_cmp_gt_u32 vcc, 10, v0
    s_getpc_b64 s[66:67]
L_pc0:
    s_and_saveexec_b64 s[80:81], vcc
    s_cbranch_execz L_nopf0
    s_lshr_b32 s60, s2, 3
    v_lshl_add_u32 v2, v0, 5, s60
    v_lshlrev_b32 v2, 7, v2
    v_min_u32 v2, L_pfend-L_pc0-4, v2
    v_mov_b32 v3, 0
    v_lshl_add_u64 v[2:3], v[2:3], 0, s[66:67]
    global_load_dword v47, v[2:3], off
L_nopf0:
    s_mov_b64 exec, -1
    s_mov_b32 s6, 2359296
    s_mov_b32 s7, 0x00020000
    s_mov_b32 s10, 1990656
    s_mov_b32 s11, 0x00020000
    s_mov_b32 s14, 663552
    s_mov_b32 s15, 0x00020000
    s_mov_b32 s18, 2359296
    s_mov_b32 s19, 0x00020000
    s_mov_b32 s26, 256
    s_mov_b32 s27, 0x00020000
    s_mov_b32 s22, 10309632
    s_mov_b32 s23, 0x00020000
    v_lshrrev_b32 v2, 6, v0
    v_and_b32 v1, 63, v0
    v_readfirstlane_b32 s28, v2
    s_and_b32 s29, s2, 7
    s_lshr_b32 s30, s2, 3
    s_mov_b32 s68, 0
    s_mov_b32 s58, 0x7ffff000
    s_mov_b32 s83, 0
    s_cmp_ge_u32 s30, 28
    s_cbranch_scc1 L_idle
    s_lshr_b32 s61, s29, 1
    s_mul_i32 s61, s61, 28
    s_add_u32 s61, s61, s30
    s_lshr_b32 s32, s61, 3
    s_and_b32 s65, s61, 7
    s_and_b32 s33, s29, 1
    s_lshl3_add_u32 s33, s33, s65
    s_and_b32 s60, s28, 1
    s_lshl_b32 s61, s60, 2
    v_lshrrev_b32 v38, 4, v1
    v_add_u32 v39, s61, v38
    v_and_b32 v40, 15, v1
    v_lshlrev_b32 v41, 1, v39
    v_xor_b32 v40, v40, v41
    s_mul_i32 s62, s28, 27648
    s_lshl_b32 s63, s32, 8
    s_add_u32 s62, s62, s63
    v_mul_u32_u24 v38, 3456, v38
    v_lshl_add_u32 v9, v40, 4, s62
    s_cmp_eq_u32 s32, 13
    s_cselect_b32 s63, 8, 0
    v_and_b32 v40, s63, v40
    v_lshl_add_u32 v38, v40, 26, v38
    v_add_u32 v9, v9, v38
    v_add_u32 v10, 12800, v9
    s_mul_i32 s62, s32, 3
    s_add_u32 s62, s62, s65
    s_mul_i32 s63, s62, 57
    s_lshr_b32 s63, s63, 9
    s_mul_i32 s63, s63, 9
    s_sub_u32 s62, s62, s63
    s_lshl_b32 s35, s62, 7
    s_mul_i32 s36, s62, 221184
    s_lshl_b32 s37, s28, 10
    s_lshl_b32 s39, s28, 11
    v_lshrrev_b32 v38, 3, v1
    v_and_b32 v40, 7, v1
    v_xor_b32 v40, v40, v39
    s_cmp_ge_u32 s32, 9
    s_cselect_b32 s63, 2, 0
    s_cselect_b32 s64, 4, 7
    s_bfe_u32 s61, s28, 0x10001
    s_lshl_b32 s61, s61, s63
    s_lshl4_add_u32 s61, s60, s61
    s_and_b32 s62, s28, 4
    s_lshl3_add_u32 s61, s62, s61
    s_lshl_b32 s62, s33, 6
    s_add_u32 s61, s61, s62
    v_and_b32 v41, s64, v38
    v_add3_u32 v41, v41, v38, s61
    v_mul_u32_u24 v41, 1152, v41
    v_lshl_add_u32 v8, v40, 4, v41
    s_lshr_b32 s60, s28, 2
    s_and_b32 s61, s28, 3
    s_lshl_b32 s62, s60, 12
    s_add_u32 s62, s62, 98304
    v_and_b32 v48, 15, v1
    v_lshrrev_b32 v49, 4, v1
    v_bfe_u32 v50, v1, 1, 3
    v_xor_b32 v50, v50, v49
    v_lshlrev_b32 v50, 4, v50
    v_lshl_add_u32 v51, v48, 7, s62
    v_add_u32 v11, v50, v51
    v_xor_b32 v12, 64, v11
    v_bfe_u32 v50, v1, 2, 2
    v_lshl_add_u32 v50, v49, 3, v50
    v_lshlrev_b32 v42, 8, v50
    v_and_b32 v50, 3, v1
    v_lshl_add_u32 v42, v50, 3, v42
    s_lshl_b32 s62, s61, 1
    v_bfe_u32 v50, v1, 2, 3
    v_xor_b32 v50, s62, v50
    v_lshl_add_u32 v42, v50, 5, v42
    v_xor_b32 v43, 32, v42
    v_add_u32 v44, 0x10000, v42
    v_add_u32 v45, 0x10000, v43
    s_waitcnt lgkmcnt(0)
    s_mov_b64 s[8:9], s[46:47]
    s_mov_b64 s[4:5], s[44:45]
    s_load_dwordx8 s[48:55], s[0:1], 16
    s_add_u32 m0, s39, 0
    s_nop 0
    buffer_load_dwordx4 v9, s[8:11], s36 offen lds
    buffer_load_dwordx4 v10, s[8:11], s36 offen offset:1024 lds
    s_add_u32 m0, s37, 98304
    s_nop 0
    buffer_load_dwordx4 v8, s[4:7], s35 offen lds
    s_add_u32 m0, s37, 106496
    s_add_u32 s35, s35, 128
    s_cmpk_eq_u32 s35, 1152
    s_cselect_b32 s35, 0, s35
    buffer_load_dwordx4 v8, s[4:7], s35 offen lds
    s_add_u32 m0, s39, 16384
    s_add_u32 s36, s36, 221184
    s_cmp_eq_u32 s36, 1990656
    s_cselect_b32 s36, 0, s36
    buffer_load_dwordx4 v9, s[8:11], s36 offen lds
    buffer_load_dwordx4 v10, s[8:11], s36 offen offset:1024 lds
    s_waitcnt lgkmcnt(0)
    s_mov_b64 s[12:13], s[48:49]
    s_mov_b64 s[16:17], s[50:51]
    s_mov_b64 s[24:25], s[52:53]
    s_mov_b64 s[20:21], s[54:55]
L_setup:
    s_lshl_b32 s41, s29, 2
    s_lshr_b32 s60, s30, 3
    s_add_u32 s41, s41, s60
    s_and_b32 s42, s30, 7
    s_and_b32 s44, s28, 3
    s_lshr_b32 s43, s28, 2
    s_mov_b32 s46, 0x3ffff
    s_mov_b32 s47, 0x3ffff
    s_mov_b32 s48, -1
    s_mov_b32 s49, 0xffff
    s_and_b32 s60, s41, 1
    s_lshr_b32 s61, s41, 1
    s_mul_i32 s61, s61, 4608
    v_and_b32 v38, 31, v1
    v_lshrrev_b32 v39, 5, v1
    s_lshl_b32 s62, s60, 11
    s_add_u32 s62, s62, s61
    s_add_u32 s62, s62, 73728
    v_lshl_add_u32 v18, v1, 4, s62
    s_mul_i32 s63, s41, 288
    v_add_u32 v40, 4294967264, v1
    v_max_i32 v40, 0, v40
    v_mul_u32_u24 v41, 3641, v40
    v_lshrrev_b32 v41, 16, v41
    v_mul_u32_u24 v41, 8928, v41
    v_lshl_add_u32 v41, v40, 4, v41
    s_add_u32 s64, s63, 145408
    v_add_u32 v19, s64, v41
    v_cmp_gt_u32 vcc, 32, v1
    s_nop 1
    v_cndmask_b32 v19, v19, v18, vcc
    v_add_u32 v40, 32, v1
    v_mul_u32_u24 v41, 3641, v40
    v_lshrrev_b32 v41, 16, v41
    v_mul_u32_u24 v41, 8928, v41
    v_lshl_add_u32 v41, v40, 4, v41
    s_add_u32 s64, s63, 144384
    v_add_u32 v20, s64, v41
    v_add_u32 v40, 96, v1
    v_mul_u32_u24 v41, 3641, v40
    v_lshrrev_b32 v41, 16, v41
    v_mul_u32_u24 v41, 8928, v41
    v_lshl_add_u32 v41, v40, 4, v41
    s_add_u32 s64, s63, 147456
    v_add_u32 v21, s64, v41
    s_mul_i32 s62, s43, 4864
    s_lshl_b32 s63, s60, 9
    s_add_u32 s63, s63, s62
    v_lshlrev_b32 v40, 10, v39
    v_lshl_add_u32 v40, v38, 3, v40
    v_add_u32 v15, s63, v40
    s_mul_i32 s63, s60, 4294965252
    s_add_u32 s63, s63, 2048
    s_add_u32 s63, s63, s62
    v_lshl_add_u32 v16, v1, 3, s63
    s_add_u32 s63, s62, 2560
    v_mul_u32_u24 v41, 288, v39
    v_lshl_add_u32 v41, v38, 4, v41
    v_add_u32 v17, s63, v41
    s_mul_i32 s63, s60, 2560
    s_add_u32 s63, s63, s61
    v_add_u32 v22, s63, v40
    s_lshl_b32 s63, s60, 2
    s_add_u32 s63, s63, s61
    s_add_u32 s63, s63, 2048
    v_lshl_add_u32 v23, v38, 3, s63
    s_lshl_b32 s63, s42, 1
    s_lshr_b32 s64, s44, 1
    s_add_u32 s63, s63, s64
    s_mul_i32 s51, s63, 221312
    s_and_b32 s64, s44, 1
    s_lshl_b32 s64, s64, 8
    s_add_u32 s51, s51, s64
    s_lshl1_add_u32 s60, s44, s43
    s_mul_i32 s45, s60, 4864
    s_mul_i32 s50, s60, 221312
    v_mov_b32 v14, 0xdddddddd
    v_mov_b32 v7, 0x422a
    v_mov_b32 v13, 0x422a
    s_and_b32 s52, s30, 3
    s_lshr_b32 s53, s30, 2
    s_and_b32 s54, s28, 3
    s_and_b32 s55, s53, 1
    s_lshl_b32 s60, s53, 2
    s_lshr_b32 s61, s53, 1
    s_add_u32 s61, s61, 32
    s_mul_i32 s62, s54, 4608
    s_add_u32 s62, s62, 9449472
    s_mul_i32 s63, s60, 18432
    s_add_u32 s70, s63, s62
    s_add_u32 s71, s70, 18432
    s_add_u32 s72, s70, 36864
    s_add_u32 s73, s70, 55296
    s_mul_i32 s63, s61, 18432
    s_add_u32 s74, s63, s62
    s_lshl2_add_u32 s62, s29, s52
    s_lshl1_add_u32 s62, s62, s55
    s_mul_i32 s63, s62, 18432
    s_lshl_b32 s61, s61, 5
    s_add_u32 s77, s61, s63
    s_mul_i32 s64, s54, 4608
    s_lshl_b32 s60, s60, 5
    s_add_u32 s60, s60, s64
    s_add_u32 s75, s60, s63
    s_xor_b32 s62, s62, 1
    s_mul_i32 s63, s62, 18432
    s_add_u32 s76, s60, s63
    s_movk_i32 s82, 272
    s_movk_i32 s59, 80
    s_lshr_b32 s60, s41, 1
    s_mul_i32 s60, s60, 36
    s_and_b32 s61, s41, 1
    s_lshl_b32 s61, s61, 4
    s_add_u32 s60, s60, s61
    v_min_u32 v40, 11, v1
    v_and_b32 v38, 1, v40
    v_mul_u32_u24 v38, 19, v38
    v_add_u32 v38, s60, v38
    v_lshrrev_b32 v41, 2, v40
    v_sub_u32 v41, 2, v41
    v_mul_u32_u24 v41, 576, v41
    v_add_u32 v38, v38, v41
    v_lshrrev_b32 v38, 7, v38
    s_lshl1_add_u32 s60, s44, s43
    s_lshr_b32 s61, s44, 1
    s_lshl1_add_u32 s61, s42, s61
    v_and_b32 v40, 2, v40
    v_lshl_add_u32 v40, v40, 2, s60
    v_mov_b32 v41, s61
    v_cmp_le_u32 vcc, 8, v1
    v_lshlrev_b32 v38, 11, v38
    v_add_u32 v38, 10113024, v38
    v_cndmask_b32 v40, v40, v41, vcc
    v_lshl_add_u32 v38, v40, 7, v38
    v_lshlrev_b32 v40, 4, v1
    v_lshlrev_b32 v41, 3, v1
    v_add_u32 v41, 4096, v41
    s_lshl_b32 s60, s44, 11
    s_add_u32 s60, s60, 155648
    v_add_u32 v26, s60, v40
    s_lshl_b32 s60, s44, 10
    s_add_u32 s60, s60, 58368
    v_add_u32 v27, s60, v40
    s_lshl2_add_u32 s60, s42, s44
    s_mul_i32 s60, s60, 36992
    s_add_u32 s60, s60, 7081984
    s_lshl_b32 s61, s41, 10
    s_add_u32 s34, s61, s60
    s_lshl_b32 s61, s41, 7
    s_add_u32 s3, s61, s60
    s_add_u32 s3, s3, 32768
    v_lshrrev_b32 v29, 4, v1
    v_and_b32 v24, 15, v1
    s_lshl_b32 s61, s55, 4
    v_add_u32 v24, s61, v24
    v_lshlrev_b32 v28, 9, v29
    v_lshl_add_u32 v28, v24, 4, v28
    v_lshlrev_b32 v29, 8, v29
    v_lshl_add_u32 v29, v24, 2, v29
    s_lshl2_add_u32 s60, s29, s52
    s_mul_i32 s60, s60, 36992
    s_add_u32 s60, s60, 7081984
    s_lshl_b32 s61, s54, 13
    s_add_u32 s12, s61, s60
    s_add_u32 s13, s12, 4096
    s_lshl_b32 s61, s54, 10
    s_add_u32 s14, s61, s60
    s_add_u32 s14, s14, 32768
    v_and_b32 v24, 15, v1
    v_lshrrev_b32 v35, 4, v1
    s_mul_i32 s60, s54, 4352
    s_add_u32 s60, s60, 72960
    v_lshl_add_u32 v30, v35, 4, s60
    v_mad_u32_u24 v30, v24, s82, v30
    s_mul_i32 s60, s54, 1280
    s_add_u32 s60, s60, 107776
    v_lshl_add_u32 v31, v35, 4, s60
    v_mad_u32_u24 v31, v24, s59, v31
    s_lshl4_add_u32 s60, s43, s54
    s_mul_i32 s60, s60, 1088
    s_add_u32 s60, s60, 72960
    v_lshl_add_u32 v32, v24, 4, s60
    v_mad_u32_u24 v32, v35, s82, v32
    v_mul_u32_u24 v34, 1152, v35
    v_lshl_add_u32 v34, v24, 3, v34
    v_lshrrev_b32 v24, 2, v1
    v_and_b32 v35, 3, v1
    v_mul_u32_u24 v33, 80, v24
    v_lshl_add_u32 v33, v35, 4, v33
    v_add_u32 v33, 107776, v33
    v_mul_u32_u24 v24, 1152, v24
    v_lshl_add_u32 v35, v35, 3, v24
    v_min_u32 v36, 17, v1
    v_lshlrev_b32 v36, 2, v36
    v_add_u32 v36, 10170368, v36
    s_lshl2_add_u32 s60, s29, s52
    s_lshl2_add_u32 s60, s60, s54
    s_lshl_b32 s60, s60, 10
    s_add_u32 s60, s60, 10178560
    v_min_u32 v37, 7, v1
    v_lshl_add_u32 v37, v37, 7, s60
    s_lshl2_add_u32 s60, s42, s44
    s_lshl_b32 s60, s60, 5
    s_add_u32 s60, s60, s41
    s_lshl_b32 s60, s60, 7
    s_add_u32 s15, s60, 10178560
    s_cmp_lg_u32 s83, 0
    s_cbranch_scc1 L_idle2
    s_lshl_b32 s60, s32, 11
    s_lshl_b32 s61, s33, 7
    s_add_u32 s60, s60, s61
    s_add_u32 s60, s60, 10113024
    s_cmp_eq_u32 s28, 0
    s_cselect_b32 s58, s60, s58
    s_lshr_b32 s60, s28, 2
    s_and_b32 s61, s28, 3
    s_mul_i32 s40, s33, 221312
    v_lshlrev_b32 v48, 4, v48
    s_lshl2_add_u32 s62, s32, s61
    s_cmp_ge_u32 s62, 54
    s_cselect_b32 s40, 0x40000000, s40
    s_mov_b32 s64, 0x3eae1a93
    s_cmp_lt_u32 s62, 18
    s_cselect_b32 s38, s64, 1.0
    s_movk_i32 s64, 256
    s_movk_i32 s65, 512
    s_cmp_ge_u32 s32, 9
    s_cselect_b32 s64, 36864, s64
    s_cselect_b32 s65, 9216, s65
    s_cselect_b32 s61, 9, 12
    s_cselect_b32 s63, 129024, 0
    s_mul_i32 s60, s60, s64
    s_lshl_b32 s62, s62, s61
    s_add_u32 s40, s40, s63
    s_add_u32 s40, s40, s62
    s_add_u32 s40, s40, s60
    v_mad_u32_u24 v46, v49, s65, v48
    s_add_u32 m0, s37, 114688
    s_add_u32 s35, s35, 128
    s_cmpk_eq_u32 s35, 1152
    s_cselect_b32 s35, 0, s35
    buffer_load_dwordx4 v8, s[4:7], s35 offen lds
    v_mov_b64 v[24:25], 0
    s_mov_b64 exec, 0xff
    buffer_store_dwordx4 v[24:27], v40, s[20:23], s58 offen sc1
    s_mov_b64 exec, -1
L_warm:
    s_mov_b64 exec, 0
    s_cmp_eq_u32 s28, 0
    s_cbranch_scc1 L_pad0
    s_cmp_eq_u32 s28, 1
    s_cbranch_scc1 L_pad1
    s_cmp_eq_u32 s28, 2
    s_cbranch_scc1 L_pad2
    s_cmp_eq_u32 s28, 3
    s_cbranch_scc1 L_pad3
    s_cmp_eq_u32 s28, 4
    s_cbranch_scc1 L_pad4
    s_cmp_eq_u32 s28, 5
    s_cbranch_scc1 L_pad5
    s_cmp_eq_u32 s28, 6
    s_cbranch_scc1 L_pad6
    s_cmp_eq_u32 s28, 7
    s_cbranch_scc1 L_pad7
L_warm_ret:
    s_mov_b64 exec, -1
    s_cmp_lg_u32 s83, 0
    s_cbranch_scc1 L_warm_idle
    s_cmp_ge_u32 s32, 9
    s_cbranch_scc1 L_p1v
    s_branch L_p1q
L_idle:
    s_waitcnt lgkmcnt(0)
    s_mov_b64 s[8:9], s[46:47]
    s_mov_b64 s[4:5], s[44:45]
    s_load_dwordx8 s[48:55], s[0:1], 16
    s_waitcnt lgkmcnt(0)
    s_mov_b64 s[12:13], s[48:49]
    s_mov_b64 s[16:17], s[50:51]
    s_mov_b64 s[24:25], s[52:53]
    s_mov_b64 s[20:21], s[54:55]
    s_cmp_lg_u32 s2, 242
    s_cbranch_scc1 L_nomaster
    s_cmp_lg_u32 s28, 0
    s_cbranch_scc1 L_nomaster
    s_mov_b32 s60, 10170880
    buffer_load_dword v2, off, s[20:23], s60 sc1
    s_waitcnt vmcnt(0)
    v_readfirstlane_b32 s61, v2
    s_mul_i32 s61, s61, 0x41c64e6d
    s_add_u32 s61, s61, 12345
    s_cmp_eq_u32 s61, 0
    s_cselect_b32 s61, 12345, s61
    v_mov_b32 v2, s61
    s_mov_b64 exec, 1
    buffer_store_dword v2, off, s[24:27], 0 sc1
    buffer_store_dword v2, off, s[20:23], s60 sc1
    s_mov_b64 exec, -1
L_nomaster:
    s_and_b32 s60, s30, 3
    s_cmp_ge_u32 s28, 4
    s_cbranch_scc1 L_pf_1
    s_lshr_b32 s61, s28, 1
    s_lshl1_add_u32 s61, s60, s61
    s_lshr_b32 s62, s29, 2
    s_mul_i32 s62, s62, 7
    s_and_b32 s63, s29, 2
    s_lshl1_add_u32 s63, s63, s61
    s_sub_u32 s64, s63, 5
    s_add_u32 s63, s63, 4
    s_cmp_lt_u32 s61, 5
    s_cselect_b32 s64, 3, s64
    s_cselect_b32 s63, s63, 8
    s_add_u32 s62, s62, s64
    s_mul_i32 s64, s62, 3
    s_add_u32 s63, s63, s64
    s_mul_i32 s64, s63, 57
    s_lshr_b32 s64, s64, 9
    s_mul_i32 s64, s64, 9
    s_sub_u32 s63, s63, s64
    s_mul_i32 s63, s63, 221184
    s_and_b32 s64, s28, 1
    s_lshl1_add_u32 s62, s62, s64
    s_lshl_b32 s62, s62, 7
    s_add_u32 s63, s63, s62
    v_mul_u32_u24 v2, 3456, v1
    buffer_load_dword v47, v2, s[8:11], s63 offen
L_pf_1:
    s_barrier
    s_and_b32 s61, s29, 6
    s_lshl1_add_u32 s60, s61, s60
    s_and_b32 s61, s29, 1
    s_lshl4_add_u32 s60, s61, s60
    s_add_u32 s60, s60, 32
    s_mul_i32 s60, s60, 36864
    s_cmp_ge_u32 s28, 5
    s_cselect_b32 s60, 0x40000000, s60
    v_min_u32 v2, 287, v0
    v_lshlrev_b32 v2, 7, v2
    buffer_load_dword v47, v2, s[4:7], s60 offen
    s_mov_b64 s[8:9], s[12:13]
    s_mov_b32 s10, 663552
    s_mov_b32 s83, 1
    s_branch L_setup
.p2align 12
L_p1q:
    s_waitcnt vmcnt(5) lgkmcnt(0)
    s_barrier
    s_add_u32 m0, s39, 32768
    s_add_u32 s36, s36, 221184
    s_cmp_eq_u32 s36, 1990656
    s_cselect_b32 s36, 0, s36
    buffer_load_dwordx4 v9, s[8:11], s36 offen lds
    buffer_load_dwordx4 v10, s[8:11], s36 offen offset:1024 lds
    ds_read_b128 v[80:83], v11 offset:0
    ds_read_b64_tr_b16 v[112:113], v42 offset:0
    ds_read_b64_tr_b16 v[114:115], v42 offset:1024
    ds_read_b128 v[84:87], v11 offset:2048
    ds_read_b64_tr_b16 v[116:117], v43 offset:0
    ds_read_b64_tr_b16 v[118:119], v43 offset:1024
    ds_read_b128 v[88:91], v12 offset:0
    ds_read_b64_tr_b16 v[120:121], v42 offset:8192
    ds_read_b64_tr_b16 v[122:123], v42 offset:9216
    ds_read_b128 v[92:95], v12 offset:2048
    ds_read_b64_tr_b16 v[124:125], v43 offset:8192
    ds_read_b64_tr_b16 v[126:127], v43 offset:9216
    s_waitcnt vmcnt(4) lgkmcnt(0)
    s_barrier
    v_mfma_f32_16x16x32_bf16 v[48:51], v[112:115], v[80:83], 0
    s_add_u32 m0, s39, 49152
    s_add_u32 s36, s36, 221184
    s_cmp_eq_u32 s36, 1990656
    s_cselect_b32 s36, 0, s36
    buffer_load_dwordx4 v9, s[8:11], s36 offen lds
    buffer_load_dwordx4 v10, s[8:11], s36 offen offset:1024 lds
    v_mfma_f32_16x16x32_bf16 v[52:55], v[112:115], v[84:87], 0
    s_add_u32 m0, s37, 122880
    s_add_u32 s35, s35, 128
    s_cmpk_eq_u32 s35, 1152
    s_cselect_b32 s35, 0, s35
    buffer_load_dwordx4 v8, s[4:7], s35 offen lds
    ds_read_b128 v[96:99], v11 offset:8192
    v_mfma_f32_16x16x32_bf16 v[56:59], v[116:119], v[80:83], 0
    ds_read_b64_tr_b16 v[128:129], v42 offset:16384
    ds_read_b64_tr_b16 v[130:131], v42 offset:17408
    v_mfma_f32_16x16x32_bf16 v[60:63], v[116:119], v[84:87], 0
    ds_read_b128 v[100:103], v11 offset:10240
    ds_read_b64_tr_b16 v[132:133], v43 offset:16384
    v_mfma_f32_16x16x32_bf16 v[48:51], v[120:123], v[88:91], v[48:51]
    ds_read_b64_tr_b16 v[134:135], v43 offset:17408
    ds_read_b128 v[104:107], v12 offset:8192
    v_mfma_f32_16x16x32_bf16 v[52:55], v[120:123], v[92:95], v[52:55]
    ds_read_b64_tr_b16 v[136:137], v42 offset:24576
    ds_read_b64_tr_b16 v[138:139], v42 offset:25600
    v_mfma_f32_16x16x32_bf16 v[56:59], v[124:127], v[88:91], v[56:59]
    ds_read_b128 v[108:111], v12 offset:10240
    ds_read_b64_tr_b16 v[140:141], v43 offset:24576
    v_mfma_f32_16x16x32_bf16 v[60:63], v[124:127], v[92:95], v[60:63]
    ds_read_b64_tr_b16 v[142:143], v43 offset:25600
    s_waitcnt vmcnt(3) lgkmcnt(0)
    s_barrier
    v_mfma_f32_16x16x32_bf16 v[48:51], v[128:131], v[96:99], v[48:51]
    s_add_u32 m0, s39, 65536
    s_add_u32 s36, s36, 221184
    s_cmp_eq_u32 s36, 1990656
    s_cselect_b32 s36, 0, s36
    buffer_load_dwordx4 v9, s[8:11], s36 offen lds
    buffer_load_dwordx4 v10, s[8:11], s36 offen offset:1024 lds
    v_mfma_f32_16x16x32_bf16 v[52:55], v[128:131], v[100:103], v[52:55]
    s_add_u32 m0, s37, 131072
    s_add_u32 s35, s35, 128
    s_cmpk_eq_u32 s35, 1152
    s_cselect_b32 s35, 0, s35
    buffer_load_dwordx4 v8, s[4:7], s35 offen lds
    ds_read_b128 v[80:83], v11 offset:16384
    v_mfma_f32_16x16x32_bf16 v[56:59], v[132:135], v[96:99], v[56:59]
    ds_read_b64_tr_b16 v[144:145], v42 offset:32768
    ds_read_b64_tr_b16 v[146:147], v42 offset:33792
    v_mfma_f32_16x16x32_bf16 v[60:63], v[132:135], v[100:103], v[60:63]
    ds_read_b128 v[84:87], v11 offset:18432
    ds_read_b64_tr_b16 v[148:149], v43 offset:32768
    v_mfma_f32_16x16x32_bf16 v[48:51], v[136:139], v[104:107], v[48:51]
    ds_read_b64_tr_b16 v[150:151], v43 offset:33792
    ds_read_b128 v[88:91], v12 offset:16384
    v_mfma_f32_16x16x32_bf16 v[52:55], v[136:139], v[108:111], v[52:55]
    ds_read_b64_tr_b16 v[152:153], v42 offset:40960
    ds_read_b64_tr_b16 v[154:155], v42 offset:41984
    v_mfma_f32_16x16x32_bf16 v[56:59], v[140:143], v[104:107], v[56:59]
    ds_read_b128 v[92:95], v12 offset:18432
    ds_read_b64_tr_b16 v[156:157], v43 offset:40960
    v_mfma_f32_16x16x32_bf16 v[60:63], v[140:143], v[108:111], v[60:63]
    ds_read_b64_tr_b16 v[158:159], v43 offset:41984
    s_waitcnt vmcnt(3) lgkmcnt(0)
    s_barrier
    v_mfma_f32_16x16x32_bf16 v[48:51], v[144:147], v[80:83], v[48:51]
    s_add_u32 m0, s39, 81920
    s_add_u32 s36, s36, 221184
    s_cmp_eq_u32 s36, 1990656
    s_cselect_b32 s36, 0, s36
    buffer_load_dwordx4 v9, s[8:11], s36 offen lds
    buffer_load_dwordx4 v10, s[8:11], s36 offen offset:1024 lds
    v_mfma_f32_16x16x32_bf16 v[52:55], v[144:147], v[84:87], v[52:55]
    s_add_u32 m0, s37, 139264
    s_add_u32 s35, s35, 128
    s_cmpk_eq_u32 s35, 1152
    s_cselect_b32 s35, 0, s35
    buffer_load_dwordx4 v8, s[4:7], s35 offen lds
    ds_read_b128 v[96:99], v11 offset:24576
    v_mfma_f32_16x16x32_bf16 v[56:59], v[148:151], v[80:83], v[56:59]
    ds_read_b64_tr_b16 v[160:161], v42 offset:49152
    ds_read_b64_tr_b16 v[162:163], v42 offset:50176
    v_mfma_f32_16x16x32_bf16 v[60:63], v[148:151], v[84:87], v[60:63]
    ds_read_b128 v[100:103], v11 offset:26624
    ds_read_b64_tr_b16 v[164:165], v43 offset:49152
    v_mfma_f32_16x16x32_bf16 v[48:51], v[152:155], v[88:91], v[48:51]
    ds_read_b64_tr_b16 v[166:167], v43 offset:50176
    ds_read_b128 v[104:107], v12 offset:24576
    v_mfma_f32_16x16x32_bf16 v[52:55], v[152:155], v[92:95], v[52:55]
    ds_read_b64_tr_b16 v[168:169], v42 offset:57344
    ds_read_b64_tr_b16 v[170:171], v42 offset:58368
    v_mfma_f32_16x16x32_bf16 v[56:59], v[156:159], v[88:91], v[56:59]
    ds_read_b128 v[108:111], v12 offset:26624
    ds_read_b64_tr_b16 v[172:173], v43 offset:57344
    v_mfma_f32_16x16x32_bf16 v[60:63], v[156:159], v[92:95], v[60:63]
    ds_read_b64_tr_b16 v[174:175], v43 offset:58368
    s_waitcnt vmcnt(3) lgkmcnt(0)
    s_barrier
    v_mfma_f32_16x16x32_bf16 v[48:51], v[160:163], v[96:99], v[48:51]
    s_add_u32 m0, s39, 0
    s_add_u32 s36, s36, 221184
    s_cmp_eq_u32 s36, 1990656
    s_cselect_b32 s36, 0, s36
    buffer_load_dwordx4 v9, s[8:11], s36 offen lds
    buffer_load_dwordx4 v10, s[8:11], s36 offen offset:1024 lds
    v_mfma_f32_16x16x32_bf16 v[52:55], v[160:163], v[100:103], v[52:55]
    s_add_u32 m0, s37, 147456
    s_add_u32 s35, s35, 128
    s_cmpk_eq_u32 s35, 1152
    s_cselect_b32 s35, 0, s35
    buffer_load_dwordx4 v8, s[4:7], s35 offen lds
    ds_read_b128 v[80:83], v11 offset:32768
    v_mfma_f32_16x16x32_bf16 v[56:59], v[164:167], v[96:99], v[56:59]
    ds_read_b64_tr_b16 v[176:177], v44 offset:0
    ds_read_b64_tr_b16 v[178:179], v44 offset:1024
    v_mfma_f32_16x16x32_bf16 v[60:63], v[164:167], v[100:103], v[60:63]
    ds_read_b128 v[84:87], v11 offset:34816
    ds_read_b64_tr_b16 v[180:181], v45 offset:0
    v_mfma_f32_16x16x32_bf16 v[48:51], v[168:171], v[104:107], v[48:51]
    ds_read_b64_tr_b16 v[182:183], v45 offset:1024
    ds_read_b128 v[88:91], v12 offset:32768
    v_mfma_f32_16x16x32_bf16 v[52:55], v[168:171], v[108:111], v[52:55]
    ds_read_b64_tr_b16 v[184:185], v44 offset:8192
    ds_read_b64_tr_b16 v[186:187], v44 offset:9216
    v_mfma_f32_16x16x32_bf16 v[56:59], v[172:175], v[104:107], v[56:59]
    ds_read_b128 v[92:95], v12 offset:34816
    ds_read_b64_tr_b16 v[188:189], v45 offset:8192
    v_mfma_f32_16x16x32_bf16 v[60:63], v[172:175], v[108:111], v[60:63]
    ds_read_b64_tr_b16 v[190:191], v45 offset:9216
    buffer_load_dword v0, off, s[24:27], 0 sc1
    s_waitcnt vmcnt(4) lgkmcnt(0)
    s_barrier
    v_mfma_f32_16x16x32_bf16 v[48:51], v[176:179], v[80:83], v[48:51]
    s_add_u32 m0, s39, 16384
    s_add_u32 s36, s36, 221184
    s_cmp_eq_u32 s36, 1990656
    s_cselect_b32 s36, 0, s36
    buffer_load_dwordx4 v9, s[8:11], s36 offen lds
    buffer_load_dwordx4 v10, s[8:11], s36 offen offset:1024 lds
    v_mfma_f32_16x16x32_bf16 v[52:55], v[176:179], v[84:87], v[52:55]
    s_add_u32 m0, s37, 155648
    s_add_u32 s35, s35, 128
    s_cmpk_eq_u32 s35, 1152
    s_cselect_b32 s35, 0, s35
    buffer_load_dwordx4 v8, s[4:7], s35 offen lds
    ds_read_b128 v[96:99], v11 offset:40960
    v_mfma_f32_16x16x32_bf16 v[56:59], v[180:183], v[80:83], v[56:59]
    ds_read_b64_tr_b16 v[192:193], v44 offset:16384
    ds_read_b64_tr_b16 v[194:195], v44 offset:17408
    v_mfma_f32_16x16x32_bf16 v[60:63], v[180:183], v[84:87], v[60:63]
    ds_read_b128 v[100:103], v11 offset:43008
    ds_read_b64_tr_b16 v[196:197], v45 offset:16384
    v_mfma_f32_16x16x32_bf16 v[48:51], v[184:187], v[88:91], v[48:51]
    ds_read_b64_tr_b16 v[198:199], v45 offset:17408
    ds_read_b128 v[104:107], v12 offset:40960
    v_mfma_f32_16x16x32_bf16 v[52:55], v[184:187], v[92:95], v[52:55]
    ds_read_b64_tr_b16 v[200:201], v44 offset:24576
    ds_read_b64_tr_b16 v[202:203], v44 offset:25600
    v_mfma_f32_16x16x32_bf16 v[56:59], v[188:191], v[88:91], v[56:59]
    ds_read_b128 v[108:111], v12 offset:43008
    ds_read_b64_tr_b16 v[204:205], v45 offset:24576
    v_mfma_f32_16x16x32_bf16 v[60:63], v[188:191], v[92:95], v[60:63]
    ds_read_b64_tr_b16 v[206:207], v45 offset:25600
    s_waitcnt vmcnt(4) lgkmcnt(0)
    s_barrier
    v_mfma_f32_16x16x32_bf16 v[48:51], v[192:195], v[96:99], v[48:51]
    s_add_u32 m0, s39, 32768
    s_add_u32 s36, s36, 221184
    s_cmp_eq_u32 s36, 1990656
    s_cselect_b32 s36, 0, s36
    buffer_load_dwordx4 v9, s[8:11], s36 offen lds
    buffer_load_dwordx4 v10, s[8:11], s36 offen offset:1024 lds
    v_mfma_f32_16x16x32_bf16 v[52:55], v[192:195], v[100:103], v[52:55]
    s_add_u32 m0, s37, 98304
    s_add_u32 s35, s35, 128
    s_cmpk_eq_u32 s35, 1152
    s_cselect_b32 s35, 0, s35
    buffer_load_dwordx4 v8, s[4:7], s35 offen lds
    ds_read_b128 v[80:83], v11 offset:49152
    v_mfma_f32_16x16x32_bf16 v[56:59], v[196:199], v[96:99], v[56:59]
    ds_read_b64_tr_b16 v[208:209], v42 offset:0
    ds_read_b64_tr_b16 v[210:211], v42 offset:1024
    v_mfma_f32_16x16x32_bf16 v[60:63], v[196:199], v[100:103], v[60:63]
    ds_read_b128 v[84:87], v11 offset:51200
    ds_read_b64_tr_b16 v[212:213], v43 offset:0
    v_mfma_f32_16x16x32_bf16 v[48:51], v[200:203], v[104:107], v[48:51]
    ds_read_b64_tr_b16 v[214:215], v43 offset:1024
    ds_read_b128 v[88:91], v12 offset:49152
    v_mfma_f32_16x16x32_bf16 v[52:55], v[200:203], v[108:111], v[52:55]
    ds_read_b64_tr_b16 v[216:217], v42 offset:8192
    ds_read_b64_tr_b16 v[218:219], v42 offset:9216
    v_mfma_f32_16x16x32_bf16 v[56:59], v[204:207], v[104:107], v[56:59]
    ds_read_b128 v[92:95], v12 offset:51200
    ds_read_b64_tr_b16 v[220:221], v43 offset:8192
    v_mfma_f32_16x16x32_bf16 v[60:63], v[204:207], v[108:111], v[60:63]
    ds_read_b64_tr_b16 v[222:223], v43 offset:9216
    s_waitcnt vmcnt(3) lgkmcnt(0)
    s_barrier
    v_mfma_f32_16x16x32_bf16 v[48:51], v[208:211], v[80:83], v[48:51]
    s_add_u32 m0, s37, 106496
    s_add_u32 s35, s35, 128
    s_cmpk_eq_u32 s35, 1152
    s_cselect_b32 s35, 0, s35
    v_add_u32 v8, 1179648, v8
    buffer_load_dwordx4 v8, s[4:7], s35 offen lds
    s_add_u32 m0, s37, 114688
    s_add_u32 s35, s35, 128
    s_cmpk_eq_u32 s35, 1152
    s_cselect_b32 s35, 0, s35
    buffer_load_dwordx4 v8, s[4:7], s35 offen lds
    v_mfma_f32_16x16x32_bf16 v[52:55], v[208:211], v[84:87], v[52:55]
    s_add_u32 m0, s37, 122880
    s_add_u32 s35, s35, 128
    s_cmpk_eq_u32 s35, 1152
    s_cselect_b32 s35, 0, s35
    buffer_load_dwordx4 v8, s[4:7], s35 offen lds
    ds_read_b128 v[96:99], v11 offset:57344
    v_mfma_f32_16x16x32_bf16 v[56:59], v[212:215], v[80:83], v[56:59]
    ds_read_b64_tr_b16 v[224:225], v42 offset:16384
    ds_read_b64_tr_b16 v[226:227], v42 offset:17408
    v_mfma_f32_16x16x32_bf16 v[60:63], v[212:215], v[84:87], v[60:63]
    ds_read_b128 v[100:103], v11 offset:59392
    ds_read_b64_tr_b16 v[228:229], v43 offset:16384
    v_mfma_f32_16x16x32_bf16 v[48:51], v[216:219], v[88:91], v[48:51]
    ds_read_b64_tr_b16 v[230:231], v43 offset:17408
    ds_read_b128 v[104:107], v12 offset:57344
    v_mfma_f32_16x16x32_bf16 v[52:55], v[216:219], v[92:95], v[52:55]
    ds_read_b64_tr_b16 v[232:233], v42 offset:24576
    ds_read_b64_tr_b16 v[234:235], v42 offset:25600
    v_mfma_f32_16x16x32_bf16 v[56:59], v[220:223], v[88:91], v[56:59]
    ds_read_b128 v[108:111], v12 offset:59392
    ds_read_b64_tr_b16 v[236:237], v43 offset:24576
    v_mfma_f32_16x16x32_bf16 v[60:63], v[220:223], v[92:95], v[60:63]
    ds_read_b64_tr_b16 v[238:239], v43 offset:25600
    s_waitcnt vmcnt(3) lgkmcnt(0)
    s_barrier
    v_mfma_f32_16x16x32_bf16 v[48:51], v[224:227], v[96:99], v[48:51]
    s_add_u32 m0, s37, 131072
    s_add_u32 s35, s35, 128
    s_cmpk_eq_u32 s35, 1152
    s_cselect_b32 s35, 0, s35
    buffer_load_dwordx4 v8, s[4:7], s35 offen lds
    s_add_u32 m0, s37, 139264
    s_add_u32 s35, s35, 128
    s_cmpk_eq_u32 s35, 1152
    s_cselect_b32 s35, 0, s35
    buffer_load_dwordx4 v8, s[4:7], s35 offen lds
    v_mfma_f32_16x16x32_bf16 v[52:55], v[224:227], v[100:103], v[52:55]
    ds_read_b128 v[80:83], v11 offset:0
    ds_read_b64_tr_b16 v[240:241], v42 offset:32768
    v_mfma_f32_16x16x32_bf16 v[56:59], v[228:231], v[96:99], v[56:59]
    ds_read_b64_tr_b16 v[242:243], v42 offset:33792
    ds_read_b128 v[84:87], v11 offset:2048
    v_mfma_f32_16x16x32_bf16 v[60:63], v[228:231], v[100:103], v[60:63]
    ds_read_b64_tr_b16 v[244:245], v43 offset:32768
    ds_read_b64_tr_b16 v[246:247], v43 offset:33792
    v_mfma_f32_16x16x32_bf16 v[48:51], v[232:235], v[104:107], v[48:51]
    ds_read_b128 v[88:91], v12 offset:0
    ds_read_b64_tr_b16 v[248:249], v42 offset:40960
    v_mfma_f32_16x16x32_bf16 v[52:55], v[232:235], v[108:111], v[52:55]
    ds_read_b64_tr_b16 v[250:251], v42 offset:41984
    ds_read_b128 v[92:95], v12 offset:2048
    v_mfma_f32_16x16x32_bf16 v[56:59], v[236:239], v[104:107], v[56:59]
    ds_read_b64_tr_b16 v[252:253], v43 offset:40960
    ds_read_b64_tr_b16 v[254:255], v43 offset:41984
    v_mfma_f32_16x16x32_bf16 v[60:63], v[236:239], v[108:111], v[60:63]
    s_waitcnt lgkmcnt(0)
    v_mfma_f32_16x16x32_bf16 v[48:51], v[240:243], v[80:83], v[48:51]
    v_mfma_f32_16x16x32_bf16 v[52:55], v[240:243], v[84:87], v[52:55]
    v_mfma_f32_16x16x32_bf16 v[56:59], v[244:247], v[80:83], v[56:59]
    v_mfma_f32_16x16x32_bf16 v[60:63], v[244:247], v[84:87], v[60:63]
    v_mfma_f32_16x16x32_bf16 v[48:51], v[248:251], v[88:91], v[48:51]
    v_mfma_f32_16x16x32_bf16 v[52:55], v[248:251], v[92:95], v[52:55]
    v_mfma_f32_16x16x32_bf16 v[56:59], v[252:255], v[88:91], v[56:59]
    v_mfma_f32_16x16x32_bf16 v[60:63], v[252:255], v[92:95], v[60:63]
    s_nop 5
    v_pk_mul_f32 v[48:49], v[48:49], s[38:39] op_sel_hi:[1,0]
    v_pk_mul_f32 v[50:51], v[50:51], s[38:39] op_sel_hi:[1,0]
    v_pk_mul_f32 v[52:53], v[52:53], s[38:39] op_sel_hi:[1,0]
    v_pk_mul_f32 v[54:55], v[54:55], s[38:39] op_sel_hi:[1,0]
    v_cvt_pk_bf16_f32 v48, v48, v49
    v_cvt_pk_bf16_f32 v49, v50, v51
    v_cvt_pk_bf16_f32 v50, v52, v53
    v_cvt_pk_bf16_f32 v51, v54, v55
    buffer_store_dwordx4 v[48:51], v46, s[20:23], s40 offen offset:0 sc1
    v_pk_mul_f32 v[56:57], v[56:57], s[38:39] op_sel_hi:[1,0]
    v_pk_mul_f32 v[58:59], v[58:59], s[38:39] op_sel_hi:[1,0]
    v_pk_mul_f32 v[60:61], v[60:61], s[38:39] op_sel_hi:[1,0]
    v_pk_mul_f32 v[62:63], v[62:63], s[38:39] op_sel_hi:[1,0]
    v_cvt_pk_bf16_f32 v56, v56, v57
    v_cvt_pk_bf16_f32 v57, v58, v59
    v_cvt_pk_bf16_f32 v58, v60, v61
    v_cvt_pk_bf16_f32 v59, v62, v63
    buffer_store_dwordx4 v[56:59], v46, s[20:23], s40 offen offset:2048 sc1
    s_add_u32 s40, s40, 3540992
    s_waitcnt vmcnt(6) lgkmcnt(0)
    s_barrier
    ds_read_b128 v[96:99], v11 offset:8192
    ds_read_b128 v[100:103], v11 offset:10240
    ds_read_b128 v[104:107], v12 offset:8192
    ds_read_b128 v[108:111], v12 offset:10240
L_tag_2:
    v_readfirstlane_b32 s31, v0
    s_cmp_eq_u32 s31, 0
    s_cbranch_scc1 L_tag_2_r
L_tag_2_k:
    s_waitcnt vmcnt(5) lgkmcnt(0)
    s_barrier
    v_mfma_f32_16x16x32_bf16 v[64:67], v[112:115], v[96:99], 0
    ds_read_b128 v[80:83], v11 offset:16384
    v_mfma_f32_16x16x32_bf16 v[68:71], v[112:115], v[100:103], 0
    ds_read_b128 v[84:87], v11 offset:18432
    v_mfma_f32_16x16x32_bf16 v[72:75], v[116:119], v[96:99], 0
    ds_read_b128 v[88:91], v12 offset:16384
    v_mfma_f32_16x16x32_bf16 v[76:79], v[116:119], v[100:103], 0
    ds_read_b128 v[92:95], v12 offset:18432
    v_mfma_f32_16x16x32_bf16 v[64:67], v[120:123], v[104:107], v[64:67]
    v_mfma_f32_16x16x32_bf16 v[68:71], v[120:123], v[108:111], v[68:71]
    v_mfma_f32_16x16x32_bf16 v[72:75], v[124:127], v[104:107], v[72:75]
    v_mfma_f32_16x16x32_bf16 v[76:79], v[124:127], v[108:111], v[76:79]
    s_waitcnt vmcnt(4) lgkmcnt(0)
    s_barrier
    v_mfma_f32_16x16x32_bf16 v[64:67], v[128:131], v[80:83], v[64:67]
    ds_read_b128 v[96:99], v11 offset:24576
    v_mfma_f32_16x16x32_bf16 v[68:71], v[128:131], v[84:87], v[68:71]
    ds_read_b128 v[100:103], v11 offset:26624
    v_mfma_f32_16x16x32_bf16 v[72:75], v[132:135], v[80:83], v[72:75]
    ds_read_b128 v[104:107], v12 offset:24576
    v_mfma_f32_16x16x32_bf16 v[76:79], v[132:135], v[84:87], v[76:79]
    ds_read_b128 v[108:111], v12 offset:26624
    v_mfma_f32_16x16x32_bf16 v[64:67], v[136:139], v[88:91], v[64:67]
    s_add_u32 m0, s37, 147456
    s_add_u32 s35, s35, 128
    s_cmpk_eq_u32 s35, 1152
    s_cselect_b32 s35, 0, s35
    buffer_load_dwordx4 v8, s[4:7], s35 offen lds
    v_mfma_f32_16x16x32_bf16 v[68:71], v[136:139], v[92:95], v[68:71]
    v_mfma_f32_16x16x32_bf16 v[72:75], v[140:143], v[88:91], v[72:75]
    v_mfma_f32_16x16x32_bf16 v[76:79], v[140:143], v[92:95], v[76:79]
    s_waitcnt vmcnt(1) lgkmcnt(0)
    s_barrier
    v_mfma_f32_16x16x32_bf16 v[64:67], v[144:147], v[96:99], v[64:67]
    s_mov_b64 exec, 1
    buffer_store_dword v0, off, s[20:23], s58 offset:0 sc1
    s_mov_b64 exec, -1
    v_mfma_f32_16x16x32_bf16 v[68:71], v[144:147], v[100:103], v[68:71]
    ds_read_b128 v[80:83], v11 offset:32768
    v_mfma_f32_16x16x32_bf16 v[72:75], v[148:151], v[96:99], v[72:75]
    ds_read_b128 v[84:87], v11 offset:34816
    v_mfma_f32_16x16x32_bf16 v[76:79], v[148:151], v[100:103], v[76:79]
    ds_read_b128 v[88:91], v12 offset:32768
    v_mfma_f32_16x16x32_bf16 v[64:67], v[152:155], v[104:107], v[64:67]
    ds_read_b128 v[92:95], v12 offset:34816
    v_mfma_f32_16x16x32_bf16 v[68:71], v[152:155], v[108:111], v[68:71]
    s_add_u32 m0, s37, 155648
    s_add_u32 s35, s35, 128
    s_cmpk_eq_u32 s35, 1152
    s_cselect_b32 s35, 0, s35
    buffer_load_dwordx4 v8, s[4:7], s35 offen lds
    v_mfma_f32_16x16x32_bf16 v[72:75], v[156:159], v[104:107], v[72:75]
    v_mfma_f32_16x16x32_bf16 v[76:79], v[156:159], v[108:111], v[76:79]
    s_waitcnt lgkmcnt(0)
    s_barrier
    v_mfma_f32_16x16x32_bf16 v[64:67], v[160:163], v[80:83], v[64:67]
    ds_read_b128 v[96:99], v11 offset:40960
    v_mfma_f32_16x16x32_bf16 v[68:71], v[160:163], v[84:87], v[68:71]
    ds_read_b128 v[100:103], v11 offset:43008
    v_mfma_f32_16x16x32_bf16 v[72:75], v[164:167], v[80:83], v[72:75]
    ds_read_b128 v[104:107], v12 offset:40960
    v_mfma_f32_16x16x32_bf16 v[76:79], v[164:167], v[84:87], v[76:79]
    ds_read_b128 v[108:111], v12 offset:43008
    v_mfma_f32_16x16x32_bf16 v[64:67], v[168:171], v[88:91], v[64:67]
    s_add_u32 m0, s37, 98304
    s_add_u32 s35, s35, 128
    s_cmpk_eq_u32 s35, 1152
    s_cselect_b32 s35, 0, s35
    buffer_load_dwordx4 v8, s[4:7], s35 offen lds
    v_mfma_f32_16x16x32_bf16 v[68:71], v[168:171], v[92:95], v[68:71]
    s_add_u32 m0, s37, 106496
    s_add_u32 s35, s35, 128
    s_cmpk_eq_u32 s35, 1152
    s_cselect_b32 s35, 0, s35
    buffer_load_dwordx4 v8, s[4:7], s35 offen lds
    v_mfma_f32_16x16x32_bf16 v[72:75], v[172:175], v[88:91], v[72:75]
    v_mfma_f32_16x16x32_bf16 v[76:79], v[172:175], v[92:95], v[76:79]
    s_waitcnt vmcnt(4) lgkmcnt(0)
    s_barrier
    v_mfma_f32_16x16x32_bf16 v[64:67], v[176:179], v[96:99], v[64:67]
    ds_read_b128 v[80:83], v11 offset:49152
    v_mfma_f32_16x16x32_bf16 v[68:71], v[176:179], v[100:103], v[68:71]
    ds_read_b128 v[84:87], v11 offset:51200
    v_mfma_f32_16x16x32_bf16 v[72:75], v[180:183], v[96:99], v[72:75]
    ds_read_b128 v[88:91], v12 offset:49152
    v_mfma_f32_16x16x32_bf16 v[76:79], v[180:183], v[100:103], v[76:79]
    ds_read_b128 v[92:95], v12 offset:51200
    v_mfma_f32_16x16x32_bf16 v[64:67], v[184:187], v[104:107], v[64:67]
    v_mfma_f32_16x16x32_bf16 v[68:71], v[184:187], v[108:111], v[68:71]
    v_mfma_f32_16x16x32_bf16 v[72:75], v[188:191], v[104:107], v[72:75]
    v_mfma_f32_16x16x32_bf16 v[76:79], v[188:191], v[108:111], v[76:79]
    s_waitcnt vmcnt(2) lgkmcnt(0)
    s_barrier
    v_mfma_f32_16x16x32_bf16 v[64:67], v[192:195], v[80:83], v[64:67]
    ds_read_b128 v[96:99], v11 offset:57344
    ds_read_b128 v[100:103], v11 offset:59392
    ds_read_b128 v[104:107], v12 offset:57344
    v_mfma_f32_16x16x32_bf16 v[68:71], v[192:195], v[84:87], v[68:71]
    ds_read_b128 v[108:111], v12 offset:59392
    buffer_load_dword v39, v38, s[20:23], 0 offen offset:0 sc1
    s_and_b32 s60, s41, 1
    v_mfma_f32_16x16x32_bf16 v[72:75], v[196:199], v[80:83], v[72:75]
    s_mul_i32 s60, s60, 4294965244
    s_add_u32 s60, s60, 2052
    s_lshl3_add_u32 s61, s28, s60
    v_mfma_f32_16x16x32_bf16 v[76:79], v[196:199], v[84:87], v[76:79]
    v_mov_b32 v158, s61
    s_lshl_b32 s61, s43, 5
    s_add_u32 s61, s61, s60
    v_mfma_f32_16x16x32_bf16 v[64:67], v[200:203], v[88:91], v[64:67]
    v_and_b32 v159, 3, v1
    v_lshl_add_u32 v159, v159, 3, s61
    s_mov_b32 s80, 0x440000
    v_mfma_f32_16x16x32_bf16 v[68:71], v[200:203], v[92:95], v[68:71]
    s_mov_b32 s81, 0x440000
    v_mov_b32 v134, 0x3f803f80
    v_cndmask_b32 v132, 0, v134, s[80:81]
    v_mfma_f32_16x16x32_bf16 v[72:75], v[204:207], v[88:91], v[72:75]
    v_mfma_f32_16x16x32_bf16 v[76:79], v[204:207], v[92:95], v[76:79]
    s_waitcnt vmcnt(2) lgkmcnt(0)
    s_barrier
    v_mfma_f32_16x16x32_bf16 v[64:67], v[208:211], v[96:99], v[64:67]
    ds_read_b128 v[80:83], v11 offset:0
    ds_read_b128 v[84:87], v11 offset:2048
    ds_read_b128 v[88:91], v12 offset:0
    v_mfma_f32_16x16x32_bf16 v[68:71], v[208:211], v[100:103], v[68:71]
    ds_read_b128 v[92:95], v12 offset:2048
    v_mov_b32 v133, v132
    v_mov_b64 v[134:135], v[132:133]
    v_mfma_f32_16x16x32_bf16 v[72:75], v[212:215], v[96:99], v[72:75]
    v_mov_b64 v[136:137], v[132:133]
    v_mov_b64 v[138:139], v[132:133]
    v_mov_b64 v[140:141], v[132:133]
    v_mfma_f32_16x16x32_bf16 v[76:79], v[212:215], v[100:103], v[76:79]
    v_mov_b64 v[142:143], v[132:133]
    v_mov_b64 v[144:145], v[132:133]
    v_mov_b64 v[146:147], v[132:133]
    v_mfma_f32_16x16x32_bf16 v[64:67], v[216:219], v[104:107], v[64:67]
    v_mov_b32 v157, 0x3f80
    v_mov_b64 v[160:161], 0
    v_mov_b64 v[162:163], 0
    v_mfma_f32_16x16x32_bf16 v[68:71], v[216:219], v[108:111], v[68:71]
    v_mov_b64 v[164:165], 0
    v_mov_b64 v[166:167], 0
    v_mfma_f32_16x16x32_bf16 v[72:75], v[220:223], v[104:107], v[72:75]
    v_mfma_f32_16x16x32_bf16 v[76:79], v[220:223], v[108:111], v[76:79]
    s_waitcnt vmcnt(0)
L_poll_3:
    v_cmp_ne_u32 vcc, s31, v39
    s_cbranch_vccnz L_poll_3_r
L_poll_3_k:
    s_waitcnt lgkmcnt(0)
    s_barrier
    s_cmp_eq_u32 s44, 3
    s_cbranch_scc1 L_fl_4
    s_add_u32 m0, s45, 0
    s_nop 0
    buffer_load_dwordx4 v18, s[20:23], s50 offen offset:0 sc1 lds
    buffer_load_dwordx4 v18, s[20:23], s50 offen offset:1024 sc1 lds
    buffer_load_dwordx4 v19, s[20:23], s50 offen offset:2048 sc1 lds
    s_cmp_ge_u32 s44, 2
    s_cbranch_scc1 L_fl_4_e
    buffer_load_dwordx4 v20, s[20:23], s50 offen offset:3072 sc1 lds
    s_add_u32 m0, m0, 4096
    s_mov_b64 exec, s[48:49]
    buffer_load_dwordx4 v21, s[20:23], s50 offen sc1 lds
    s_mov_b64 exec, -1
    s_branch L_fl_4_e
L_fl_4:
    s_lshl1_add_u32 s61, s42, s43
    s_mul_i32 s61, s61, 221312
    s_mul_i32 s60, s43, 2560
    s_add_u32 m0, s60, 155648
    v_subrev_u32 v24, 73728, v18
    buffer_load_dwordx4 v24, s[20:23], s61 offen offset:0 sc1 lds
    buffer_load_dwordx4 v24, s[20:23], s61 offen offset:1024 sc1 lds
    s_mov_b32 exec_hi, 0
    buffer_load_dwordx4 v24, s[20:23], s61 offen offset:2048 sc1 lds
    s_mov_b64 exec, -1
L_fl_4_e:
    v_mfma_f32_16x16x32_bf16 v[64:67], v[224:227], v[80:83], v[64:67]
    ds_read_b128 v[96:99], v11 offset:8192
    ds_read_b128 v[100:103], v11 offset:10240
    v_mfma_f32_16x16x32_bf16 v[68:71], v[224:227], v[84:87], v[68:71]
    ds_read_b128 v[104:107], v12 offset:8192
    ds_read_b128 v[108:111], v12 offset:10240
    v_mfma_f32_16x16x32_bf16 v[72:75], v[228:231], v[80:83], v[72:75]
    v_mov_b64 v[168:169], 0
    v_mov_b64 v[170:171], 0
    v_mfma_f32_16x16x32_bf16 v[76:79], v[228:231], v[84:87], v[76:79]
    v_mov_b64 v[172:173], 0
    v_mov_b64 v[174:175], 0
    v_mfma_f32_16x16x32_bf16 v[64:67], v[232:235], v[88:91], v[64:67]
    v_mov_b64 v[176:177], 0
    v_mov_b64 v[178:179], 0
    v_mfma_f32_16x16x32_bf16 v[68:71], v[232:235], v[92:95], v[68:71]
    v_mov_b64 v[180:181], 0
    v_mov_b64 v[182:183], 0
    v_mfma_f32_16x16x32_bf16 v[72:75], v[236:239], v[88:91], v[72:75]
    v_mov_b64 v[184:185], 0
    v_mov_b64 v[186:187], 0
    v_mfma_f32_16x16x32_bf16 v[76:79], v[236:239], v[92:95], v[76:79]
    v_mov_b64 v[188:189], 0
    v_mov_b64 v[190:191], 0
    s_waitcnt lgkmcnt(0)
    v_mfma_f32_16x16x32_bf16 v[64:67], v[240:243], v[96:99], v[64:67]
    v_mfma_f32_16x16x32_bf16 v[68:71], v[240:243], v[100:103], v[68:71]
    v_mfma_f32_16x16x32_bf16 v[72:75], v[244:247], v[96:99], v[72:75]
    v_mfma_f32_16x16x32_bf16 v[76:79], v[244:247], v[100:103], v[76:79]
    v_mfma_f32_16x16x32_bf16 v[64:67], v[248:251], v[104:107], v[64:67]
    v_mfma_f32_16x16x32_bf16 v[68:71], v[248:251], v[108:111], v[68:71]
    v_mfma_f32_16x16x32_bf16 v[72:75], v[252:255], v[104:107], v[72:75]
    v_mfma_f32_16x16x32_bf16 v[76:79], v[252:255], v[108:111], v[76:79]
    s_nop 5
    v_pk_mul_f32 v[64:65], v[64:65], s[38:39] op_sel_hi:[1,0]
    v_pk_mul_f32 v[66:67], v[66:67], s[38:39] op_sel_hi:[1,0]
    v_pk_mul_f32 v[68:69], v[68:69], s[38:39] op_sel_hi:[1,0]
    v_pk_mul_f32 v[70:71], v[70:71], s[38:39] op_sel_hi:[1,0]
    v_cvt_pk_bf16_f32 v64, v64, v65
    v_cvt_pk_bf16_f32 v65, v66, v67
    v_cvt_pk_bf16_f32 v66, v68, v69
    v_cvt_pk_bf16_f32 v67, v70, v71
    v_pk_mul_f32 v[72:73], v[72:73], s[38:39] op_sel_hi:[1,0]
    v_pk_mul_f32 v[74:75], v[74:75], s[38:39] op_sel_hi:[1,0]
    v_pk_mul_f32 v[76:77], v[76:77], s[38:39] op_sel_hi:[1,0]
    v_pk_mul_f32 v[78:79], v[78:79], s[38:39] op_sel_hi:[1,0]
    v_cvt_pk_bf16_f32 v72, v72, v73
    v_cvt_pk_bf16_f32 v73, v74, v75
    v_cvt_pk_bf16_f32 v74, v76, v77
    v_cvt_pk_bf16_f32 v75, v78, v79
    s_add_u32 s39, s40, 2048
    s_cmp_lg_u32 s44, 3
    s_cbranch_scc1 L_fl_5
    s_add_u32 m0, s45, 0
    s_nop 0
    buffer_load_dwordx4 v18, s[20:23], s50 offen offset:0 sc1 lds
    buffer_load_dwordx4 v18, s[20:23], s50 offen offset:1024 sc1 lds
    buffer_load_dwordx4 v19, s[20:23], s50 offen offset:2048 sc1 lds
L_fl_5:
    s_cmp_lt_u32 s44, 2
    s_cbranch_scc1 L_fl_5_e
    buffer_load_dwordx4 v20, s[20:23], s50 offen offset:3072 sc1 lds
    s_add_u32 m0, m0, 4096
    s_mov_b64 exec, s[48:49]
    buffer_load_dwordx4 v21, s[20:23], s50 offen sc1 lds
    s_mov_b64 exec, -1
L_fl_5_e:
    s_cmp_lg_u32 s43, 0
    s_cbranch_scc1 L_attn1
    s_branch L_attn0
L_poll_3_r:
    s_add_u32 s68, s68, 1
    s_cmp_gt_u32 s68, 0x80000
    s_cbranch_scc1 L_poll_3_k
    buffer_load_dword v39, v38, s[20:23], 0 offen offset:0 sc1
    s_waitcnt vmcnt(0)
    s_branch L_poll_3
.p2align 12
L_p1v:
    s_waitcnt vmcnt(5) lgkmcnt(0)
    s_barrier
    s_add_u32 m0, s39, 32768
    s_add_u32 s36, s36, 221184
    s_cmp_eq_u32 s36, 1990656
    s_cselect_b32 s36, 0, s36
    buffer_load_dwordx4 v9, s[8:11], s36 offen lds
    buffer_load_dwordx4 v10, s[8:11], s36 offen offset:1024 lds
    ds_read_b128 v[80:83], v11 offset:0
    ds_read_b64_tr_b16 v[112:113], v42 offset:0
    ds_read_b64_tr_b16 v[114:115], v42 offset:1024
    ds_read_b128 v[84:87], v11 offset:2048
    ds_read_b64_tr_b16 v[116:117], v43 offset:0
    ds_read_b64_tr_b16 v[118:119], v43 offset:1024
    ds_read_b128 v[88:91], v12 offset:0
    ds_read_b64_tr_b16 v[120:121], v42 offset:8192
    ds_read_b64_tr_b16 v[122:123], v42 offset:9216
    ds_read_b128 v[92:95], v12 offset:2048
    ds_read_b64_tr_b16 v[124:125], v43 offset:8192
    ds_read_b64_tr_b16 v[126:127], v43 offset:9216
    s_waitcnt vmcnt(4) lgkmcnt(0)
    s_barrier
    v_mfma_f32_16x16x32_bf16 v[48:51], v[80:83], v[112:115], 0
    s_add_u32 m0, s39, 49152
    s_add_u32 s36, s36, 221184
    s_cmp_eq_u32 s36, 1990656
    s_cselect_b32 s36, 0, s36
    buffer_load_dwordx4 v9, s[8:11], s36 offen lds
    buffer_load_dwordx4 v10, s[8:11], s36 offen offset:1024 lds
    v_mfma_f32_16x16x32_bf16 v[52:55], v[84:87], v[112:115], 0
    s_add_u32 m0, s37, 122880
    s_add_u32 s35, s35, 128
    s_cmpk_eq_u32 s35, 1152
    s_cselect_b32 s35, 0, s35
    buffer_load_dwordx4 v8, s[4:7], s35 offen lds
    ds_read_b128 v[96:99], v11 offset:8192
    v_mfma_f32_16x16x32_bf16 v[56:59], v[80:83], v[116:119], 0
    ds_read_b64_tr_b16 v[128:129], v42 offset:16384
    ds_read_b64_tr_b16 v[130:131], v42 offset:17408
    v_mfma_f32_16x16x32_bf16 v[60:63], v[84:87], v[116:119], 0
    ds_read_b128 v[100:103], v11 offset:10240
    ds_read_b64_tr_b16 v[132:133], v43 offset:16384
    v_mfma_f32_16x16x32_bf16 v[48:51], v[88:91], v[120:123], v[48:51]
    ds_read_b64_tr_b16 v[134:135], v43 offset:17408
    ds_read_b128 v[104:107], v12 offset:8192
    v_mfma_f32_16x16x32_bf16 v[52:55], v[92:95], v[120:123], v[52:55]
    ds_read_b64_tr_b16 v[136:137], v42 offset:24576
    ds_read_b64_tr_b16 v[138:139], v42 offset:25600
    v_mfma_f32_16x16x32_bf16 v[56:59], v[88:91], v[124:127], v[56:59]
    ds_read_b128 v[108:111], v12 offset:10240
    ds_read_b64_tr_b16 v[140:141], v43 offset:24576
    v_mfma_f32_16x16x32_bf16 v[60:63], v[92:95], v[124:127], v[60:63]
    ds_read_b64_tr_b16 v[142:143], v43 offset:25600
    s_waitcnt vmcnt(3) lgkmcnt(0)
    s_barrier
    v_mfma_f32_16x16x32_bf16 v[48:51], v[96:99], v[128:131], v[48:51]
    s_add_u32 m0, s39, 65536
    s_add_u32 s36, s36, 221184
    s_cmp_eq_u32 s36, 1990656
    s_cselect_b32 s36, 0, s36
    buffer_load_dwordx4 v9, s[8:11], s36 offen lds
    buffer_load_dwordx4 v10, s[8:11], s36 offen offset:1024 lds
    v_mfma_f32_16x16x32_bf16 v[52:55], v[100:103], v[128:131], v[52:55]
    s_add_u32 m0, s37, 131072
    s_add_u32 s35, s35, 128
    s_cmpk_eq_u32 s35, 1152
    s_cselect_b32 s35, 0, s35
    buffer_load_dwordx4 v8, s[4:7], s35 offen lds
    ds_read_b128 v[80:83], v11 offset:16384
    v_mfma_f32_16x16x32_bf16 v[56:59], v[96:99], v[132:135], v[56:59]
    ds_read_b64_tr_b16 v[144:145], v42 offset:32768
    ds_read_b64_tr_b16 v[146:147], v42 offset:33792
    v_mfma_f32_16x16x32_bf16 v[60:63], v[100:103], v[132:135], v[60:63]
    ds_read_b128 v[84:87], v11 offset:18432
    ds_read_b64_tr_b16 v[148:149], v43 offset:32768
    v_mfma_f32_16x16x32_bf16 v[48:51], v[104:107], v[136:139], v[48:51]
    ds_read_b64_tr_b16 v[150:151], v43 offset:33792
    ds_read_b128 v[88:91], v12 offset:16384
    v_mfma_f32_16x16x32_bf16 v[52:55], v[108:111], v[136:139], v[52:55]
    ds_read_b64_tr_b16 v[152:153], v42 offset:40960
    ds_read_b64_tr_b16 v[154:155], v42 offset:41984
    v_mfma_f32_16x16x32_bf16 v[56:59], v[104:107], v[140:143], v[56:59]
    ds_read_b128 v[92:95], v12 offset:18432
    ds_read_b64_tr_b16 v[156:157], v43 offset:40960
    v_mfma_f32_16x16x32_bf16 v[60:63], v[108:111], v[140:143], v[60:63]
    ds_read_b64_tr_b16 v[158:159], v43 offset:41984
    s_waitcnt vmcnt(3) lgkmcnt(0)
    s_barrier
    v_mfma_f32_16x16x32_bf16 v[48:51], v[80:83], v[144:147], v[48:51]
    s_add_u32 m0, s39, 81920
    s_add_u32 s36, s36, 221184
    s_cmp_eq_u32 s36, 1990656
    s_cselect_b32 s36, 0, s36
    buffer_load_dwordx4 v9, s[8:11], s36 offen lds
    buffer_load_dwordx4 v10, s[8:11], s36 offen offset:1024 lds
    v_mfma_f32_16x16x32_bf16 v[52:55], v[84:87], v[144:147], v[52:55]
    s_add_u32 m0, s37, 139264
    s_add_u32 s35, s35, 128
    s_cmpk_eq_u32 s35, 1152
    s_cselect_b32 s35, 0, s35
    buffer_load_dwordx4 v8, s[4:7], s35 offen lds
    ds_read_b128 v[96:99], v11 offset:24576
    v_mfma_f32_16x16x32_bf16 v[56:59], v[80:83], v[148:151], v[56:59]
    ds_read_b64_tr_b16 v[160:161], v42 offset:49152
    ds_read_b64_tr_b16 v[162:163], v42 offset:50176
    v_mfma_f32_16x16x32_bf16 v[60:63], v[84:87], v[148:151], v[60:63]
    ds_read_b128 v[100:103], v11 offset:26624
    ds_read_b64_tr_b16 v[164:165], v43 offset:49152
    v_mfma_f32_16x16x32_bf16 v[48:51], v[88:91], v[152:155], v[48:51]
    ds_read_b64_tr_b16 v[166:167], v43 offset:50176
    ds_read_b128 v[104:107], v12 offset:24576
    v_mfma_f32_16x16x32_bf16 v[52:55], v[92:95], v[152:155], v[52:55]
    ds_read_b64_tr_b16 v[168:169], v42 offset:57344
    ds_read_b64_tr_b16 v[170:171], v42 offset:58368
    v_mfma_f32_16x16x32_bf16 v[56:59], v[88:91], v[156:159], v[56:59]
    ds_read_b128 v[108:111], v12 offset:26624
    ds_read_b64_tr_b16 v[172:173], v43 offset:57344
    v_mfma_f32_16x16x32_bf16 v[60:63], v[92:95], v[156:159], v[60:63]
    ds_read_b64_tr_b16 v[174:175], v43 offset:58368
    s_waitcnt vmcnt(3) lgkmcnt(0)
    s_barrier
    v_mfma_f32_16x16x32_bf16 v[48:51], v[96:99], v[160:163], v[48:51]
    s_add_u32 m0, s39, 0
    s_add_u32 s36, s36, 221184
    s_cmp_eq_u32 s36, 1990656
    s_cselect_b32 s36, 0, s36
    buffer_load_dwordx4 v9, s[8:11], s36 offen lds
    buffer_load_dwordx4 v10, s[8:11], s36 offen offset:1024 lds
    v_mfma_f32_16x16x32_bf16 v[52:55], v[100:103], v[160:163], v[52:55]
    s_add_u32 m0, s37, 147456
    s_add_u32 s35, s35, 128
    s_cmpk_eq_u32 s35, 1152
    s_cselect_b32 s35, 0, s35
    buffer_load_dwordx4 v8, s[4:7], s35 offen lds
    ds_read_b128 v[80:83], v11 offset:32768
    v_mfma_f32_16x16x32_bf16 v[56:59], v[96:99], v[164:167], v[56:59]
    ds_read_b64_tr_b16 v[176:177], v44 offset:0
    ds_read_b64_tr_b16 v[178:179], v44 offset:1024
    v_mfma_f32_16x16x32_bf16 v[60:63], v[100:103], v[164:167], v[60:63]
    ds_read_b128 v[84:87], v11 offset:34816
    ds_read_b64_tr_b16 v[180:181], v45 offset:0
    v_mfma_f32_16x16x32_bf16 v[48:51], v[104:107], v[168:171], v[48:51]
    ds_read_b64_tr_b16 v[182:183], v45 offset:1024
    ds_read_b128 v[88:91], v12 offset:32768
    v_mfma_f32_16x16x32_bf16 v[52:55], v[108:111], v[168:171], v[52:55]
    ds_read_b64_tr_b16 v[184:185], v44 offset:8192
    ds_read_b64_tr_b16 v[186:187], v44 offset:9216
    v_mfma_f32_16x16x32_bf16 v[56:59], v[104:107], v[172:175], v[56:59]
    ds_read_b128 v[92:95], v12 offset:34816
    ds_read_b64_tr_b16 v[188:189], v45 offset:8192
    v_mfma_f32_16x16x32_bf16 v[60:63], v[108:111], v[172:175], v[60:63]
    ds_read_b64_tr_b16 v[190:191], v45 offset:9216
    buffer_load_dword v0, off, s[24:27], 0 sc1
    s_waitcnt vmcnt(4) lgkmcnt(0)
    s_barrier
    v_mfma_f32_16x16x32_bf16 v[48:51], v[80:83], v[176:179], v[48:51]
    s_add_u32 m0, s39, 16384
    s_add_u32 s36, s36, 221184
    s_cmp_eq_u32 s36, 1990656
    s_cselect_b32 s36, 0, s36
    buffer_load_dwordx4 v9, s[8:11], s36 offen lds
    buffer_load_dwordx4 v10, s[8:11], s36 offen offset:1024 lds
    v_mfma_f32_16x16x32_bf16 v[52:55], v[84:87], v[176:179], v[52:55]
    s_add_u32 m0, s37, 155648
    s_add_u32 s35, s35, 128
    s_cmpk_eq_u32 s35, 1152
    s_cselect_b32 s35, 0, s35
    buffer_load_dwordx4 v8, s[4:7], s35 offen lds
    ds_read_b128 v[96:99], v11 offset:40960
    v_mfma_f32_16x16x32_bf16 v[56:59], v[80:83], v[180:183], v[56:59]
    ds_read_b64_tr_b16 v[192:193], v44 offset:16384
    ds_read_b64_tr_b16 v[194:195], v44 offset:17408
    v_mfma_f32_16x16x32_bf16 v[60:63], v[84:87], v[180:183], v[60:63]
    ds_read_b128 v[100:103], v11 offset:43008
    ds_read_b64_tr_b16 v[196:197], v45 offset:16384
    v_mfma_f32_16x16x32_bf16 v[48:51], v[88:91], v[184:187], v[48:51]
    ds_read_b64_tr_b16 v[198:199], v45 offset:17408
    ds_read_b128 v[104:107], v12 offset:40960
    v_mfma_f32_16x16x32_bf16 v[52:55], v[92:95], v[184:187], v[52:55]
    ds_read_b64_tr_b16 v[200:201], v44 offset:24576
    ds_read_b64_tr_b16 v[202:203], v44 offset:25600
    v_mfma_f32_16x16x32_bf16 v[56:59], v[88:91], v[188:191], v[56:59]
    ds_read_b128 v[108:111], v12 offset:43008
    ds_read_b64_tr_b16 v[204:205], v45 offset:24576
    v_mfma_f32_16x16x32_bf16 v[60:63], v[92:95], v[188:191], v[60:63]
    ds_read_b64_tr_b16 v[206:207], v45 offset:25600
    s_waitcnt vmcnt(4) lgkmcnt(0)
    s_barrier
    v_mfma_f32_16x16x32_bf16 v[48:51], v[96:99], v[192:195], v[48:51]
    s_add_u32 m0, s39, 32768
    s_add_u32 s36, s36, 221184
    s_cmp_eq_u32 s36, 1990656
    s_cselect_b32 s36, 0, s36
    buffer_load_dwordx4 v9, s[8:11], s36 offen lds
    buffer_load_dwordx4 v10, s[8:11], s36 offen offset:1024 lds
    v_mfma_f32_16x16x32_bf16 v[52:55], v[100:103], v[192:195], v[52:55]
    s_add_u32 m0, s37, 98304
    s_add_u32 s35, s35, 128
    s_cmpk_eq_u32 s35, 1152
    s_cselect_b32 s35, 0, s35
    buffer_load_dwordx4 v8, s[4:7], s35 offen lds
    ds_read_b128 v[80:83], v11 offset:49152
    v_mfma_f32_16x16x32_bf16 v[56:59], v[96:99], v[196:199], v[56:59]
    ds_read_b64_tr_b16 v[208:209], v42 offset:0
    ds_read_b64_tr_b16 v[210:211], v42 offset:1024
    v_mfma_f32_16x16x32_bf16 v[60:63], v[100:103], v[196:199], v[60:63]
    ds_read_b128 v[84:87], v11 offset:51200
    ds_read_b64_tr_b16 v[212:213], v43 offset:0
    v_mfma_f32_16x16x32_bf16 v[48:51], v[104:107], v[200:203], v[48:51]
    ds_read_b64_tr_b16 v[214:215], v43 offset:1024
    ds_read_b128 v[88:91], v12 offset:49152
    v_mfma_f32_16x16x32_bf16 v[52:55], v[108:111], v[200:203], v[52:55]
    ds_read_b64_tr_b16 v[216:217], v42 offset:8192
    ds_read_b64_tr_b16 v[218:219], v42 offset:9216
    v_mfma_f32_16x16x32_bf16 v[56:59], v[104:107], v[204:207], v[56:59]
    ds_read_b128 v[92:95], v12 offset:51200
    ds_read_b64_tr_b16 v[220:221], v43 offset:8192
    v_mfma_f32_16x16x32_bf16 v[60:63], v[108:111], v[204:207], v[60:63]
    ds_read_b64_tr_b16 v[222:223], v43 offset:9216
    s_waitcnt vmcnt(3) lgkmcnt(0)
    s_barrier
    v_mfma_f32_16x16x32_bf16 v[48:51], v[80:83], v[208:211], v[48:51]
    s_add_u32 m0, s37, 106496
    s_add_u32 s35, s35, 128
    s_cmpk_eq_u32 s35, 1152
    s_cselect_b32 s35, 0, s35
    v_add_u32 v8, 1179648, v8
    buffer_load_dwordx4 v8, s[4:7], s35 offen lds
    s_add_u32 m0, s37, 114688
    s_add_u32 s35, s35, 128
    s_cmpk_eq_u32 s35, 1152
    s_cselect_b32 s35, 0, s35
    buffer_load_dwordx4 v8, s[4:7], s35 offen lds
    v_mfma_f32_16x16x32_bf16 v[52:55], v[84:87], v[208:211], v[52:55]
    s_add_u32 m0, s37, 122880
    s_add_u32 s35, s35, 128
    s_cmpk_eq_u32 s35, 1152
    s_cselect_b32 s35, 0, s35
    buffer_load_dwordx4 v8, s[4:7], s35 offen lds
    ds_read_b128 v[96:99], v11 offset:57344
    v_mfma_f32_16x16x32_bf16 v[56:59], v[80:83], v[212:215], v[56:59]
    ds_read_b64_tr_b16 v[224:225], v42 offset:16384
    ds_read_b64_tr_b16 v[226:227], v42 offset:17408
    v_mfma_f32_16x16x32_bf16 v[60:63], v[84:87], v[212:215], v[60:63]
    ds_read_b128 v[100:103], v11 offset:59392
    ds_read_b64_tr_b16 v[228:229], v43 offset:16384
    v_mfma_f32_16x16x32_bf16 v[48:51], v[88:91], v[216:219], v[48:51]
    ds_read_b64_tr_b16 v[230:231], v43 offset:17408
    ds_read_b128 v[104:107], v12 offset:57344
    v_mfma_f32_16x16x32_bf16 v[52:55], v[92:95], v[216:219], v[52:55]
    ds_read_b64_tr_b16 v[232:233], v42 offset:24576
    ds_read_b64_tr_b16 v[234:235], v42 offset:25600
    v_mfma_f32_16x16x32_bf16 v[56:59], v[88:91], v[220:223], v[56:59]
    ds_read_b128 v[108:111], v12 offset:59392
    ds_read_b64_tr_b16 v[236:237], v43 offset:24576
    v_mfma_f32_16x16x32_bf16 v[60:63], v[92:95], v[220:223], v[60:63]
    ds_read_b64_tr_b16 v[238:239], v43 offset:25600
    s_waitcnt vmcnt(3) lgkmcnt(0)
    s_barrier
    v_mfma_f32_16x16x32_bf16 v[48:51], v[96:99], v[224:227], v[48:51]
    s_add_u32 m0, s37, 131072
    s_add_u32 s35, s35, 128
    s_cmpk_eq_u32 s35, 1152
    s_cselect_b32 s35, 0, s35
    buffer_load_dwordx4 v8, s[4:7], s35 offen lds
    s_add_u32 m0, s37, 139264
    s_add_u32 s35, s35, 128
    s_cmpk_eq_u32 s35, 1152
    s_cselect_b32 s35, 0, s35
    buffer_load_dwordx4 v8, s[4:7], s35 offen lds
    v_mfma_f32_16x16x32_bf16 v[52:55], v[100:103], v[224:227], v[52:55]
    ds_read_b128 v[80:83], v11 offset:0
    ds_read_b64_tr_b16 v[240:241], v42 offset:32768
    v_mfma_f32_16x16x32_bf16 v[56:59], v[96:99], v[228:231], v[56:59]
    ds_read_b64_tr_b16 v[242:243], v42 offset:33792
    ds_read_b128 v[84:87], v11 offset:2048
    v_mfma_f32_16x16x32_bf16 v[60:63], v[100:103], v[228:231], v[60:63]
    ds_read_b64_tr_b16 v[244:245], v43 offset:32768
    ds_read_b64_tr_b16 v[246:247], v43 offset:33792
    v_mfma_f32_16x16x32_bf16 v[48:51], v[104:107], v[232:235], v[48:51]
    ds_read_b128 v[88:91], v12 offset:0
    ds_read_b64_tr_b16 v[248:249], v42 offset:40960
    v_mfma_f32_16x16x32_bf16 v[52:55], v[108:111], v[232:235], v[52:55]
    ds_read_b64_tr_b16 v[250:251], v42 offset:41984
    ds_read_b128 v[92:95], v12 offset:2048
    v_mfma_f32_16x16x32_bf16 v[56:59], v[104:107], v[236:239], v[56:59]
    ds_read_b64_tr_b16 v[252:253], v43 offset:40960
    ds_read_b64_tr_b16 v[254:255], v43 offset:41984
    v_mfma_f32_16x16x32_bf16 v[60:63], v[108:111], v[236:239], v[60:63]
    s_waitcnt lgkmcnt(0)
    v_mfma_f32_16x16x32_bf16 v[48:51], v[80:83], v[240:243], v[48:51]
    v_mfma_f32_16x16x32_bf16 v[52:55], v[84:87], v[240:243], v[52:55]
    v_mfma_f32_16x16x32_bf16 v[56:59], v[80:83], v[244:247], v[56:59]
    v_mfma_f32_16x16x32_bf16 v[60:63], v[84:87], v[244:247], v[60:63]
    v_mfma_f32_16x16x32_bf16 v[48:51], v[88:91], v[248:251], v[48:51]
    v_mfma_f32_16x16x32_bf16 v[52:55], v[92:95], v[248:251], v[52:55]
    v_mfma_f32_16x16x32_bf16 v[56:59], v[88:91], v[252:255], v[56:59]
    v_mfma_f32_16x16x32_bf16 v[60:63], v[92:95], v[252:255], v[60:63]
    s_nop 5
    v_cvt_pk_bf16_f32 v48, v48, v49
    v_cvt_pk_bf16_f32 v49, v50, v51
    v_cvt_pk_bf16_f32 v50, v52, v53
    v_cvt_pk_bf16_f32 v51, v54, v55
    buffer_store_dwordx4 v[48:51], v46, s[20:23], s40 offen offset:0 sc1
    v_cvt_pk_bf16_f32 v56, v56, v57
    v_cvt_pk_bf16_f32 v57, v58, v59
    v_cvt_pk_bf16_f32 v58, v60, v61
    v_cvt_pk_bf16_f32 v59, v62, v63
    buffer_store_dwordx4 v[56:59], v46, s[20:23], s40 offen offset:256 sc1
    s_add_u32 s40, s40, 3540992
    s_waitcnt vmcnt(6) lgkmcnt(0)
    s_barrier
    ds_read_b128 v[96:99], v11 offset:8192
    ds_read_b128 v[100:103], v11 offset:10240
    ds_read_b128 v[104:107], v12 offset:8192
    ds_read_b128 v[108:111], v12 offset:10240
L_tag_6:
    v_readfirstlane_b32 s31, v0
    s_cmp_eq_u32 s31, 0
    s_cbranch_scc1 L_tag_6_r
L_tag_6_k:
    s_waitcnt vmcnt(5) lgkmcnt(0)
    s_barrier
    v_mfma_f32_16x16x32_bf16 v[64:67], v[96:99], v[112:115], 0
    ds_read_b128 v[80:83], v11 offset:16384
    v_mfma_f32_16x16x32_bf16 v[68:71], v[100:103], v[112:115], 0
    ds_read_b128 v[84:87], v11 offset:18432
    v_mfma_f32_16x16x32_bf16 v[72:75], v[96:99], v[116:119], 0
    ds_read_b128 v[88:91], v12 offset:16384
    v_mfma_f32_16x16x32_bf16 v[76:79], v[100:103], v[116:119], 0
    ds_read_b128 v[92:95], v12 offset:18432
    v_mfma_f32_16x16x32_bf16 v[64:67], v[104:107], v[120:123], v[64:67]
    v_mfma_f32_16x16x32_bf16 v[68:71], v[108:111], v[120:123], v[68:71]
    v_mfma_f32_16x16x32_bf16 v[72:75], v[104:107], v[124:127], v[72:75]
    v_mfma_f32_16x16x32_bf16 v[76:79], v[108:111], v[124:127], v[76:79]
    s_waitcnt vmcnt(4) lgkmcnt(0)
    s_barrier
    v_mfma_f32_16x16x32_bf16 v[64:67], v[80:83], v[128:131], v[64:67]
    ds_read_b128 v[96:99], v11 offset:24576
    v_mfma_f32_16x16x32_bf16 v[68:71], v[84:87], v[128:131], v[68:71]
    ds_read_b128 v[100:103], v11 offset:26624
    v_mfma_f32_16x16x32_bf16 v[72:75], v[80:83], v[132:135], v[72:75]
    ds_read_b128 v[104:107], v12 offset:24576
    v_mfma_f32_16x16x32_bf16 v[76:79], v[84:87], v[132:135], v[76:79]
    ds_read_b128 v[108:111], v12 offset:26624
    v_mfma_f32_16x16x32_bf16 v[64:67], v[88:91], v[136:139], v[64:67]
    s_add_u32 m0, s37, 147456
    s_add_u32 s35, s35, 128
    s_cmpk_eq_u32 s35, 1152
    s_cselect_b32 s35, 0, s35
    buffer_load_dwordx4 v8, s[4:7], s35 offen lds
    v_mfma_f32_16x16x32_bf16 v[68:71], v[92:95], v[136:139], v[68:71]
    v_mfma_f32_16x16x32_bf16 v[72:75], v[88:91], v[140:143], v[72:75]
    v_mfma_f32_16x16x32_bf16 v[76:79], v[92:95], v[140:143], v[76:79]
    s_waitcnt vmcnt(1) lgkmcnt(0)
    s_barrier
    v_mfma_f32_16x16x32_bf16 v[64:67], v[96:99], v[144:147], v[64:67]
    s_mov_b64 exec, 1
    buffer_store_dword v0, off, s[20:23], s58 offset:0 sc1
    s_mov_b64 exec, -1
    v_mfma_f32_16x16x32_bf16 v[68:71], v[100:103], v[144:147], v[68:71]
    ds_read_b128 v[80:83], v11 offset:32768
    v_mfma_f32_16x16x32_bf16 v[72:75], v[96:99], v[148:151], v[72:75]
    ds_read_b128 v[84:87], v11 offset:34816
    v_mfma_f32_16x16x32_bf16 v[76:79], v[100:103], v[148:151], v[76:79]
    ds_read_b128 v[88:91], v12 offset:32768
    v_mfma_f32_16x16x32_bf16 v[64:67], v[104:107], v[152:155], v[64:67]
    ds_read_b128 v[92:95], v12 offset:34816
    v_mfma_f32_16x16x32_bf16 v[68:71], v[108:111], v[152:155], v[68:71]
    s_add_u32 m0, s37, 155648
    s_add_u32 s35, s35, 128
    s_cmpk_eq_u32 s35, 1152
    s_cselect_b32 s35, 0, s35
    buffer_load_dwordx4 v8, s[4:7], s35 offen lds
    v_mfma_f32_16x16x32_bf16 v[72:75], v[104:107], v[156:159], v[72:75]
    v_mfma_f32_16x16x32_bf16 v[76:79], v[108:111], v[156:159], v[76:79]
    s_waitcnt lgkmcnt(0)
    s_barrier
    v_mfma_f32_16x16x32_bf16 v[64:67], v[80:83], v[160:163], v[64:67]
    ds_read_b128 v[96:99], v11 offset:40960
    v_mfma_f32_16x16x32_bf16 v[68:71], v[84:87], v[160:163], v[68:71]
    ds_read_b128 v[100:103], v11 offset:43008
    v_mfma_f32_16x16x32_bf16 v[72:75], v[80:83], v[164:167], v[72:75]
    ds_read_b128 v[104:107], v12 offset:40960
    v_mfma_f32_16x16x32_bf16 v[76:79], v[84:87], v[164:167], v[76:79]
    ds_read_b128 v[108:111], v12 offset:43008
    v_mfma_f32_16x16x32_bf16 v[64:67], v[88:91], v[168:171], v[64:67]
    s_add_u32 m0, s37, 98304
    s_add_u32 s35, s35, 128
    s_cmpk_eq_u32 s35, 1152
    s_cselect_b32 s35, 0, s35
    buffer_load_dwordx4 v8, s[4:7], s35 offen lds
    v_mfma_f32_16x16x32_bf16 v[68:71], v[92:95], v[168:171], v[68:71]
    s_add_u32 m0, s37, 106496
    s_add_u32 s35, s35, 128
    s_cmpk_eq_u32 s35, 1152
    s_cselect_b32 s35, 0, s35
    buffer_load_dwordx4 v8, s[4:7], s35 offen lds
    v_mfma_f32_16x16x32_bf16 v[72:75], v[88:91], v[172:175], v[72:75]
    v_mfma_f32_16x16x32_bf16 v[76:79], v[92:95], v[172:175], v[76:79]
    s_waitcnt vmcnt(4) lgkmcnt(0)
    s_barrier
    v_mfma_f32_16x16x32_bf16 v[64:67], v[96:99], v[176:179], v[64:67]
    ds_read_b128 v[80:83], v11 offset:49152
    v_mfma_f32_16x16x32_bf16 v[68:71], v[100:103], v[176:179], v[68:71]
    ds_read_b128 v[84:87], v11 offset:51200
    v_mfma_f32_16x16x32_bf16 v[72:75], v[96:99], v[180:183], v[72:75]
    ds_read_b128 v[88:91], v12 offset:49152
    v_mfma_f32_16x16x32_bf16 v[76:79], v[100:103], v[180:183], v[76:79]
    ds_read_b128 v[92:95], v12 offset:51200
    v_mfma_f32_16x16x32_bf16 v[64:67], v[104:107], v[184:187], v[64:67]
    v_mfma_f32_16x16x32_bf16 v[68:71], v[108:111], v[184:187], v[68:71]
    v_mfma_f32_16x16x32_bf16 v[72:75], v[104:107], v[188:191], v[72:75]
    v_mfma_f32_16x16x32_bf16 v[76:79], v[108:111], v[188:191], v[76:79]
    s_waitcnt vmcnt(2) lgkmcnt(0)
    s_barrier
    v_mfma_f32_16x16x32_bf16 v[64:67], v[80:83], v[192:195], v[64:67]
    ds_read_b128 v[96:99], v11 offset:57344
    ds_read_b128 v[100:103], v11 offset:59392
    ds_read_b128 v[104:107], v12 offset:57344
    v_mfma_f32_16x16x32_bf16 v[68:71], v[84:87], v[192:195], v[68:71]
    ds_read_b128 v[108:111], v12 offset:59392
    buffer_load_dword v39, v38, s[20:23], 0 offen offset:0 sc1
    s_and_b32 s60, s41, 1
    v_mfma_f32_16x16x32_bf16 v[72:75], v[80:83], v[196:199], v[72:75]
    s_mul_i32 s60, s60, 4294965244
    s_add_u32 s60, s60, 2052
    s_lshl3_add_u32 s61, s28, s60
    v_mfma_f32_16x16x32_bf16 v[76:79], v[84:87], v[196:199], v[76:79]
    v_mov_b32 v158, s61
    s_lshl_b32 s61, s43, 5
    s_add_u32 s61, s61, s60
    v_mfma_f32_16x16x32_bf16 v[64:67], v[88:91], v[200:203], v[64:67]
    v_and_b32 v159, 3, v1
    v_lshl_add_u32 v159, v159, 3, s61
    s_mov_b32 s80, 0x440000
    v_mfma_f32_16x16x32_bf16 v[68:71], v[92:95], v[200:203], v[68:71]
    s_mov_b32 s81, 0x440000
    v_mov_b32 v134, 0x3f803f80
    v_cndmask_b32 v132, 0, v134, s[80:81]
    v_mfma_f32_16x16x32_bf16 v[72:75], v[88:91], v[204:207], v[72:75]
    v_mfma_f32_16x16x32_bf16 v[76:79], v[92:95], v[204:207], v[76:79]
    s_waitcnt vmcnt(2) lgkmcnt(0)
    s_barrier
    v_mfma_f32_16x16x32_bf16 v[64:67], v[96:99], v[208:211], v[64:67]
    ds_read_b128 v[80:83], v11 offset:0
    ds_read_b128 v[84:87], v11 offset:2048
    ds_read_b128 v[88:91], v12 offset:0
    v_mfma_f32_16x16x32_bf16 v[68:71], v[100:103], v[208:211], v[68:71]
    ds_read_b128 v[92:95], v12 offset:2048
    v_mov_b32 v133, v132
    v_mov_b64 v[134:135], v[132:133]
    v_mfma_f32_16x16x32_bf16 v[72:75], v[96:99], v[212:215], v[72:75]
    v_mov_b64 v[136:137], v[132:133]
    v_mov_b64 v[138:139], v[132:133]
    v_mov_b64 v[140:141], v[132:133]
    v_mfma_f32_16x16x32_bf16 v[76:79], v[100:103], v[212:215], v[76:79]
    v_mov_b64 v[142:143], v[132:133]
    v_mov_b64 v[144:145], v[132:133]
    v_mov_b64 v[146:147], v[132:133]
    v_mfma_f32_16x16x32_bf16 v[64:67], v[104:107], v[216:219], v[64:67]
    v_mov_b32 v157, 0x3f80
    v_mov_b64 v[160:161], 0
    v_mov_b64 v[162:163], 0
    v_mfma_f32_16x16x32_bf16 v[68:71], v[108:111], v[216:219], v[68:71]
    v_mov_b64 v[164:165], 0
    v_mov_b64 v[166:167], 0
    v_mfma_f32_16x16x32_bf16 v[72:75], v[104:107], v[220:223], v[72:75]
    v_mfma_f32_16x16x32_bf16 v[76:79], v[108:111], v[220:223], v[76:79]
    s_waitcnt vmcnt(0)
L_poll_7:
    v_cmp_ne_u32 vcc, s31, v39
    s_cbranch_vccnz L_poll_7_r
L_poll_7_k:
    s_waitcnt lgkmcnt(0)
    s_barrier
    s_cmp_eq_u32 s44, 3
    s_cbranch_scc1 L_fl_8
    s_add_u32 m0, s45, 0
    s_nop 0
    buffer_load_dwordx4 v18, s[20:23], s50 offen offset:0 sc1 lds
    buffer_load_dwordx4 v18, s[20:23], s50 offen offset:1024 sc1 lds
    buffer_load_dwordx4 v19, s[20:23], s50 offen offset:2048 sc1 lds
    s_cmp_ge_u32 s44, 2
    s_cbranch_scc1 L_fl_8_e
    buffer_load_dwordx4 v20, s[20:23], s50 offen offset:3072 sc1 lds
    s_add_u32 m0, m0, 4096
    s_mov_b64 exec, s[48:49]
    buffer_load_dwordx4 v21, s[20:23], s50 offen sc1 lds
    s_mov_b64 exec, -1
    s_branch L_fl_8_e
L_fl_8:
    s_lshl1_add_u32 s61, s42, s43
    s_mul_i32 s61, s61, 221312
    s_mul_i32 s60, s43, 2560
    s_add_u32 m0, s60, 155648
    v_subrev_u32 v24, 73728, v18
    buffer_load_dwordx4 v24, s[20:23], s61 offen offset:0 sc1 lds
    buffer_load_dwordx4 v24, s[20:23], s61 offen offset:1024 sc1 lds
    s_mov_b32 exec_hi, 0
    buffer_load_dwordx4 v24, s[20:23], s61 offen offset:2048 sc1 lds
    s_mov_b64 exec, -1
L_fl_8_e:
    v_mfma_f32_16x16x32_bf16 v[64:67], v[80:83], v[224:227], v[64:67]
    ds_read_b128 v[96:99], v11 offset:8192
    ds_read_b128 v[100:103], v11 offset:10240
    v_mfma_f32_16x16x32_bf16 v[68:71], v[84:87], v[224:227], v[68:71]
    ds_read_b128 v[104:107], v12 offset:8192
    ds_read_b128 v[108:111], v12 offset:10240
    v_mfma_f32_16x16x32_bf16 v[72:75], v[80:83], v[228:231], v[72:75]
    v_mov_b64 v[168:169], 0
    v_mov_b64 v[170:171], 0
    v_mfma_f32_16x16x32_bf16 v[76:79], v[84:87], v[228:231], v[76:79]
    v_mov_b64 v[172:173], 0
    v_mov_b64 v[174:175], 0
    v_mfma_f32_16x16x32_bf16 v[64:67], v[88:91], v[232:235], v[64:67]
    v_mov_b64 v[176:177], 0
    v_mov_b64 v[178:179], 0
    v_mfma_f32_16x16x32_bf16 v[68:71], v[92:95], v[232:235], v[68:71]
    v_mov_b64 v[180:181], 0
    v_mov_b64 v[182:183], 0
    v_mfma_f32_16x16x32_bf16 v[72:75], v[88:91], v[236:239], v[72:75]
    v_mov_b64 v[184:185], 0
    v_mov_b64 v[186:187], 0
    v_mfma_f32_16x16x32_bf16 v[76:79], v[92:95], v[236:239], v[76:79]
    v_mov_b64 v[188:189], 0
    v_mov_b64 v[190:191], 0
    s_waitcnt lgkmcnt(0)
    v_mfma_f32_16x16x32_bf16 v[64:67], v[96:99], v[240:243], v[64:67]
    v_mfma_f32_16x16x32_bf16 v[68:71], v[100:103], v[240:243], v[68:71]
    v_mfma_f32_16x16x32_bf16 v[72:75], v[96:99], v[244:247], v[72:75]
    v_mfma_f32_16x16x32_bf16 v[76:79], v[100:103], v[244:247], v[76:79]
    v_mfma_f32_16x16x32_bf16 v[64:67], v[104:107], v[248:251], v[64:67]
    v_mfma_f32_16x16x32_bf16 v[68:71], v[108:111], v[248:251], v[68:71]
    v_mfma_f32_16x16x32_bf16 v[72:75], v[104:107], v[252:255], v[72:75]
    v_mfma_f32_16x16x32_bf16 v[76:79], v[108:111], v[252:255], v[76:79]
    s_nop 5
    v_cvt_pk_bf16_f32 v64, v64, v65
    v_cvt_pk_bf16_f32 v65, v66, v67
    v_cvt_pk_bf16_f32 v66, v68, v69
    v_cvt_pk_bf16_f32 v67, v70, v71
    v_cvt_pk_bf16_f32 v72, v72, v73
    v_cvt_pk_bf16_f32 v73, v74, v75
    v_cvt_pk_bf16_f32 v74, v76, v77
    v_cvt_pk_bf16_f32 v75, v78, v79
    s_add_u32 s39, s40, 256
    s_cmp_lg_u32 s44, 3
    s_cbranch_scc1 L_fl_9
    s_add_u32 m0, s45, 0
    s_nop 0
    buffer_load_dwordx4 v18, s[20:23], s50 offen offset:0 sc1 lds
    buffer_load_dwordx4 v18, s[20:23], s50 offen offset:1024 sc1 lds
    buffer_load_dwordx4 v19, s[20:23], s50 offen offset:2048 sc1 lds
L_fl_9:
    s_cmp_lt_u32 s44, 2
    s_cbranch_scc1 L_fl_9_e
    buffer_load_dwordx4 v20, s[20:23], s50 offen offset:3072 sc1 lds
    s_add_u32 m0, m0, 4096
    s_mov_b64 exec, s[48:49]
    buffer_load_dwordx4 v21, s[20:23], s50 offen sc1 lds
    s_mov_b64 exec, -1
L_fl_9_e:
    s_cmp_lg_u32 s43, 0
    s_cbranch_scc1 L_attn1
    s_branch L_attn0
L_poll_7_r:
    s_add_u32 s68, s68, 1
    s_cmp_gt_u32 s68, 0x80000
    s_cbranch_scc1 L_poll_7_k
    buffer_load_dword v39, v38, s[20:23], 0 offen offset:0 sc1
    s_waitcnt vmcnt(0)
    s_branch L_poll_7
.p2align 12
L_attn:
    s_cmp_lg_u32 s43, 0
    s_cbranch_scc1 L_attn1
L_attn0:
L_pad0:
    s_cbranch_execz L_warm_ret
    s_lshr_b32 s60, s44, 1
    s_mul_i32 s60, s60, 2560
    s_and_b32 s61, s44, 1
    s_lshl_b32 s61, s61, 8
    s_add_u32 s60, s60, s61
    s_mul_i32 s61, s43, 4864
    s_sub_u32 s60, s60, s61
    s_add_u32 s60, s60, 155648
    v_add_u32 v24, s60, v15
    v_and_b32 v25, 32, v1
    v_lshlrev_b32 v25, 3, v25
    v_sub_u32 v25, v16, v25
    v_add_u32 v25, s60, v25
    s_setprio 3
    s_waitcnt vmcnt(5)
    s_cmp_eq_u32 s44, 3
    s_cbranch_scc1 L_b0_10
    s_waitcnt vmcnt(2)
    s_cmp_eq_u32 s44, 2
    s_cbranch_scc1 L_b0_10
    s_waitcnt vmcnt(0)
L_b0_10:
    s_barrier
    ds_read_b32 v6, v25
    ds_read_b64 v[2:3], v24 offset:0
    ds_read_b64 v[4:5], v24 offset:512
    ds_read_b32 v156, v16 offset:0
    ds_read_b64 v[148:149], v15 offset:0
    ds_read_b64 v[150:151], v15 offset:512
    ds_read_b64 v[152:153], v15 offset:256
    ds_read_b64 v[154:155], v15 offset:768
    s_mov_b64 exec, s[46:47]
    ds_read_b128 v[132:135], v17 offset:0
    ds_read_b128 v[136:139], v17 offset:576
    ds_read_b128 v[140:143], v17 offset:1152
    ds_read_b128 v[144:147], v17 offset:1728
    s_mov_b64 exec, -1
    s_waitcnt lgkmcnt(8)
    v_mfma_f32_32x32x4_2b_bf16 v[192:223], v[156:157], v[6:7], 0
    ds_read_b32 v156, v16 offset:9728
    s_add_u32 m0, s45, 38912
    s_add_u32 s50, s50, 1770496
    buffer_load_dwordx4 v18, s[20:23], s50 offen offset:0 sc1 lds
    buffer_load_dwordx4 v18, s[20:23], s50 offen offset:1024 sc1 lds
    buffer_load_dwordx4 v19, s[20:23], s50 offen offset:2048 sc1 lds
    s_nop 11
    s_waitcnt lgkmcnt(7)
    v_mfma_f32_32x32x16_bf16 v[192:207], v[148:151], v[2:5], v[192:207]
    ds_read_b64 v[148:149], v15 offset:9728
    ds_read_b64 v[150:151], v15 offset:10240
    s_waitcnt lgkmcnt(7)
    v_mfma_f32_32x32x16_bf16 v[208:223], v[152:155], v[2:5], v[208:223]
    ds_read_b64 v[152:153], v15 offset:9984
    ds_read_b64 v[154:155], v15 offset:10496
    s_nop 7
    v_exp_f32 v192, v192
    v_exp_f32 v193, v193
    v_exp_f32 v194, v194
    v_exp_f32 v195, v195
    v_exp_f32 v196, v196
    v_exp_f32 v197, v197
    s_waitcnt lgkmcnt(4)
    v_mfma_f32_32x32x4_2b_bf16 v[224:255], v[156:157], v[6:7], 0
    buffer_load_dwordx4 v20, s[20:23], s50 offen offset:3072 sc1 lds
    s_add_u32 m0, m0, 4096
    s_mov_b64 exec, s[48:49]
    buffer_load_dwordx4 v21, s[20:23], s50 offen sc1 lds
    s_mov_b64 exec, -1
    v_exp_f32 v198, v198
    v_exp_f32 v199, v199
    v_exp_f32 v200, v200
    v_exp_f32 v201, v201
    v_exp_f32 v202, v202
    v_exp_f32 v203, v203
    v_exp_f32 v204, v204
    v_exp_f32 v205, v205
    v_smfmac_f32_32x32x32_bf16 v[160:175], v[132:135], v[192:199], v14
    v_exp_f32 v206, v206
    v_exp_f32 v207, v207
    v_exp_f32 v208, v208
    v_exp_f32 v209, v209
    v_smfmac_f32_32x32x32_bf16 v[160:175], v[136:139], v[200:207], v14
    s_mov_b64 exec, s[46:47]
    ds_read_b128 v[132:135], v17 offset:9728
    ds_read_b128 v[136:139], v17 offset:10304
    s_mov_b64 exec, -1
    buffer_store_dwordx4 v[64:67], v46, s[20:23], s40 offen sc1
    v_exp_f32 v210, v210
    v_exp_f32 v211, v211
    v_exp_f32 v212, v212
    v_exp_f32 v213, v213
    s_waitcnt lgkmcnt(4)
    v_mfma_f32_32x32x16_bf16 v[224:239], v[148:151], v[2:5], v[224:239]
    ds_read_b32 v156, v16 offset:19456
    ds_read_b64 v[148:149], v15 offset:19456
    ds_read_b64 v[150:151], v15 offset:19968
    s_setprio 2
    buffer_store_dwordx4 v[72:75], v46, s[20:23], s39 offen sc1
    v_exp_f32 v214, v214
    v_exp_f32 v215, v215
    v_exp_f32 v216, v216
    v_exp_f32 v217, v217
    v_smfmac_f32_32x32x32_bf16 v[160:175], v[140:143], v[208:215], v14
    v_exp_f32 v218, v218
    v_exp_f32 v219, v219
    v_exp_f32 v220, v220
    v_exp_f32 v221, v221
    s_waitcnt lgkmcnt(5)
    v_mfma_f32_32x32x16_bf16 v[240:255], v[152:155], v[2:5], v[240:255]
    ds_read_b64 v[152:153], v15 offset:19712
    ds_read_b64 v[154:155], v15 offset:20224
    v_exp_f32 v222, v222
    v_exp_f32 v223, v223
    v_exp_f32 v224, v224
    v_exp_f32 v225, v225
    v_smfmac_f32_32x32x32_bf16 v[160:175], v[144:147], v[216:223], v14
    s_mov_b64 exec, s[46:47]
    ds_read_b128 v[140:143], v17 offset:10880
    ds_read_b128 v[144:147], v17 offset:11456
    s_mov_b64 exec, -1
    s_waitcnt vmcnt(7)
    s_mov_b64 exec, 1
    ds_write_b32 v158, v0 offset:0
    s_mov_b64 exec, -1
    v_exp_f32 v226, v226
    v_exp_f32 v227, v227
    v_exp_f32 v228, v228
    v_exp_f32 v229, v229
    s_waitcnt lgkmcnt(7)
    v_mfma_f32_32x32x4_2b_bf16 v[192:223], v[156:157], v[6:7], 0
    v_exp_f32 v230, v230
    v_exp_f32 v231, v231
    v_exp_f32 v232, v232
    v_exp_f32 v233, v233
    v_exp_f32 v234, v234
    v_exp_f32 v235, v235
    v_exp_f32 v236, v236
    v_exp_f32 v237, v237
    v_smfmac_f32_32x32x32_bf16 v[160:175], v[132:135], v[224:231], v14
    ds_read_b32 v24, v159 offset:0
    v_exp_f32 v238, v238
    v_exp_f32 v239, v239
    v_exp_f32 v240, v240
    v_exp_f32 v241, v241
    v_smfmac_f32_32x32x32_bf16 v[160:175], v[136:139], v[232:239], v14
    s_waitcnt lgkmcnt(0)
L_word_11:
    v_cmp_ne_u32 vcc, s31, v24
    s_cbranch_vccnz L_word_11_r
L_word_11_k:
    s_mov_b64 exec, s[46:47]
    ds_read_b128 v[132:135], v17 offset:19456
    ds_read_b128 v[136:139], v17 offset:20032
    s_mov_b64 exec, -1
    v_exp_f32 v242, v242
    v_exp_f32 v243, v243
    v_exp_f32 v244, v244
    v_exp_f32 v245, v245
    v_mfma_f32_32x32x16_bf16 v[192:207], v[148:151], v[2:5], v[192:207]
    ds_read_b32 v156, v16 offset:29184
    ds_read_b64 v[148:149], v15 offset:29184
    ds_read_b64 v[150:151], v15 offset:29696
    v_exp_f32 v246, v246
    v_exp_f32 v247, v247
    v_exp_f32 v248, v248
    v_exp_f32 v249, v249
    v_smfmac_f32_32x32x32_bf16 v[160:175], v[140:143], v[240:247], v14
    v_exp_f32 v250, v250
    v_exp_f32 v251, v251
    v_exp_f32 v252, v252
    v_exp_f32 v253, v253
    v_mfma_f32_32x32x16_bf16 v[208:223], v[152:155], v[2:5], v[208:223]
    ds_read_b64 v[152:153], v15 offset:29440
    ds_read_b64 v[154:155], v15 offset:29952
    s_waitcnt vmcnt(2)
    s_mov_b64 exec, 1
    ds_write_b32 v158, v0 offset:64
    s_mov_b64 exec, -1
    v_exp_f32 v254, v254
    v_exp_f32 v255, v255
    v_exp_f32 v192, v192
    v_exp_f32 v193, v193
    v_smfmac_f32_32x32x32_bf16 v[160:175], v[144:147], v[248:255], v14
    s_mov_b64 exec, s[46:47]
    ds_read_b128 v[140:143], v17 offset:20608
    ds_read_b128 v[144:147], v17 offset:21184
    s_mov_b64 exec, -1
    v_exp_f32 v194, v194
    v_exp_f32 v195, v195
    v_exp_f32 v196, v196
    v_exp_f32 v197, v197
    s_waitcnt lgkmcnt(7)
    v_mfma_f32_32x32x4_2b_bf16 v[224:255], v[156:157], v[6:7], 0
    v_exp_f32 v198, v198
    v_exp_f32 v199, v199
    v_exp_f32 v200, v200
    v_exp_f32 v201, v201
    v_exp_f32 v202, v202
    v_exp_f32 v203, v203
    v_exp_f32 v204, v204
    v_exp_f32 v205, v205
    v_smfmac_f32_32x32x32_bf16 v[160:175], v[132:135], v[192:199], v14
    s_setprio 1
    v_exp_f32 v206, v206
    v_exp_f32 v207, v207
    v_exp_f32 v208, v208
    v_exp_f32 v209, v209
    v_smfmac_f32_32x32x32_bf16 v[160:175], v[136:139], v[200:207], v14
    s_mov_b64 exec, s[46:47]
    ds_read_b128 v[132:135], v17 offset:29184
    ds_read_b128 v[136:139], v17 offset:29760
    s_mov_b64 exec, -1
    ds_read_b32 v24, v159 offset:64
    v_exp_f32 v210, v210
    v_exp_f32 v211, v211
    v_exp_f32 v212, v212
    v_exp_f32 v213, v213
    s_waitcnt lgkmcnt(8)
    v_mfma_f32_32x32x16_bf16 v[224:239], v[148:151], v[2:5], v[224:239]
    s_waitcnt lgkmcnt(0)
L_word_12:
    v_cmp_ne_u32 vcc, s31, v24
    s_cbranch_vccnz L_word_12_r
L_word_12_k:
    ds_read_b32 v156, v16 offset:38912
    ds_read_b64 v[148:149], v15 offset:38912
    ds_read_b64 v[150:151], v15 offset:39424
    s_waitcnt vmcnt(0)
    s_mov_b64 exec, 1
    ds_write_b32 v158, v0 offset:4864
    s_mov_b64 exec, -1
    v_exp_f32 v214, v214
    v_exp_f32 v215, v215
    v_exp_f32 v216, v216
    v_exp_f32 v217, v217
    v_smfmac_f32_32x32x32_bf16 v[160:175], v[140:143], v[208:215], v14
    v_exp_f32 v218, v218
    v_exp_f32 v219, v219
    v_exp_f32 v220, v220
    v_exp_f32 v221, v221
    v_mfma_f32_32x32x16_bf16 v[240:255], v[152:155], v[2:5], v[240:255]
    ds_read_b64 v[152:153], v15 offset:39168
    ds_read_b64 v[154:155], v15 offset:39680
    v_exp_f32 v222, v222
    v_exp_f32 v223, v223
    v_exp_f32 v224, v224
    v_exp_f32 v225, v225
    v_smfmac_f32_32x32x32_bf16 v[160:175], v[144:147], v[216:223], v14
    s_mov_b64 exec, s[46:47]
    ds_read_b128 v[140:143], v17 offset:30336
    ds_read_b128 v[144:147], v17 offset:30912
    s_mov_b64 exec, -1
    ds_read_b32 v24, v159 offset:4864
    ds_read_b32 v25, v159 offset:4896
    v_exp_f32 v226, v226
    v_exp_f32 v227, v227
    v_exp_f32 v228, v228
    v_exp_f32 v229, v229
    s_waitcnt lgkmcnt(9)
    v_mfma_f32_32x32x4_2b_bf16 v[192:223], v[156:157], v[6:7], 0
    s_waitcnt lgkmcnt(0)
L_word_13:
    v_cmp_ne_u32 vcc, s31, v24
    s_cbranch_vccnz L_word_13_r
    v_cmp_ne_u32 vcc, s31, v25
    s_cbranch_vccnz L_word_13_r
L_word_13_k:
    s_mov_b64 exec, 1
    buffer_store_dword v0, off, s[20:23], s58 offset:4 sc1
    s_mov_b64 exec, -1
    v_exp_f32 v230, v230
    v_exp_f32 v231, v231
    v_exp_f32 v232, v232
    v_exp_f32 v233, v233
    v_exp_f32 v234, v234
    v_exp_f32 v235, v235
    v_exp_f32 v236, v236
    v_exp_f32 v237, v237
    v_smfmac_f32_32x32x32_bf16 v[160:175], v[132:135], v[224:231], v14
    v_exp_f32 v238, v238
    v_exp_f32 v239, v239
    v_exp_f32 v240, v240
    v_exp_f32 v241, v241
    v_smfmac_f32_32x32x32_bf16 v[160:175], v[136:139], v[232:239], v14
    s_mov_b64 exec, s[46:47]
    ds_read_b128 v[132:135], v17 offset:38912
    ds_read_b128 v[136:139], v17 offset:39488
    s_mov_b64 exec, -1
    v_exp_f32 v242, v242
    v_exp_f32 v243, v243
    v_exp_f32 v244, v244
    v_exp_f32 v245, v245
    v_mfma_f32_32x32x16_bf16 v[192:207], v[148:151], v[2:5], v[192:207]
    ds_read_b32 v156, v16 offset:48640
    ds_read_b64 v[148:149], v15 offset:48640
    ds_read_b64 v[150:151], v15 offset:49152
    v_exp_f32 v246, v246
    v_exp_f32 v247, v247
    v_exp_f32 v248, v248
    v_exp_f32 v249, v249
    v_smfmac_f32_32x32x32_bf16 v[160:175], v[140:143], v[240:247], v14
    v_exp_f32 v250, v250
    v_exp_f32 v251, v251
    v_exp_f32 v252, v252
    v_exp_f32 v253, v253
    v_mfma_f32_32x32x16_bf16 v[208:223], v[152:155], v[2:5], v[208:223]
    ds_read_b64 v[152:153], v15 offset:48896
    ds_read_b64 v[154:155], v15 offset:49408
    v_exp_f32 v254, v254
    v_exp_f32 v255, v255
    v_exp_f32 v192, v192
    v_exp_f32 v193, v193
    v_smfmac_f32_32x32x32_bf16 v[160:175], v[144:147], v[248:255], v14
    s_mov_b64 exec, s[46:47]
    ds_read_b128 v[140:143], v17 offset:40064
    ds_read_b128 v[144:147], v17 offset:40640
    s_mov_b64 exec, -1
    v_exp_f32 v194, v194
    v_exp_f32 v195, v195
    v_exp_f32 v196, v196
    v_exp_f32 v197, v197
    s_waitcnt lgkmcnt(6)
    v_mfma_f32_32x32x4_2b_bf16 v[224:255], v[156:157], v[6:7], 0
    v_exp_f32 v198, v198
    v_exp_f32 v199, v199
    v_exp_f32 v200, v200
    v_exp_f32 v201, v201
    v_exp_f32 v202, v202
    v_exp_f32 v203, v203
    v_exp_f32 v204, v204
    v_exp_f32 v205, v205
    v_smfmac_f32_32x32x32_bf16 v[160:175], v[132:135], v[192:199], v14
    v_exp_f32 v206, v206
    v_exp_f32 v207, v207
    v_exp_f32 v208, v208
    v_exp_f32 v209, v209
    v_smfmac_f32_32x32x32_bf16 v[160:175], v[136:139], v[200:207], v14
    s_mov_b64 exec, s[46:47]
    ds_read_b128 v[132:135], v17 offset:48640
    ds_read_b128 v[136:139], v17 offset:49216
    s_mov_b64 exec, -1
    v_exp_f32 v210, v210
    v_exp_f32 v211, v211
    v_exp_f32 v212, v212
    v_exp_f32 v213, v213
    s_waitcnt lgkmcnt(6)
    v_mfma_f32_32x32x16_bf16 v[224:239], v[148:151], v[2:5], v[224:239]
    v_add_u32 v16, 0xe400, v16
    ds_read_b32 v156, v16 offset:0
    v_add_u32 v15, 0xe400, v15
    ds_read_b64 v[148:149], v15 offset:0
    ds_read_b64 v[150:151], v15 offset:512
    v_exp_f32 v214, v214
    v_exp_f32 v215, v215
    v_exp_f32 v216, v216
    v_exp_f32 v217, v217
    s_waitcnt lgkmcnt(5)
    v_smfmac_f32_32x32x32_bf16 v[160:175], v[140:143], v[208:215], v14
    v_exp_f32 v218, v218
    v_exp_f32 v219, v219
    v_exp_f32 v220, v220
    v_exp_f32 v221, v221
    v_mfma_f32_32x32x16_bf16 v[240:255], v[152:155], v[2:5], v[240:255]
    ds_read_b64 v[152:153], v15 offset:256
    ds_read_b64 v[154:155], v15 offset:768
    v_exp_f32 v222, v222
    v_exp_f32 v223, v223
    v_exp_f32 v224, v224
    v_exp_f32 v225, v225
    v_smfmac_f32_32x32x32_bf16 v[160:175], v[144:147], v[216:223], v14
    s_mov_b64 exec, s[46:47]
    ds_read_b128 v[140:143], v17 offset:49792
    ds_read_b128 v[144:147], v17 offset:50368
    s_mov_b64 exec, -1
    buffer_load_dword v39, v38, s[20:23], 0 offen offset:4 sc1
    v_exp_f32 v226, v226
    v_exp_f32 v227, v227
    v_exp_f32 v228, v228
    v_exp_f32 v229, v229
    s_waitcnt lgkmcnt(6)
    v_mfma_f32_32x32x4_2b_bf16 v[192:223], v[156:157], v[6:7], 0
    v_exp_f32 v230, v230
    v_exp_f32 v231, v231
    v_exp_f32 v232, v232
    v_exp_f32 v233, v233
    v_exp_f32 v234, v234
    v_exp_f32 v235, v235
    v_exp_f32 v236, v236
    v_exp_f32 v237, v237
    v_smfmac_f32_32x32x32_bf16 v[160:175], v[132:135], v[224:231], v14
    v_exp_f32 v238, v238
    v_exp_f32 v239, v239
    v_exp_f32 v240, v240
    v_exp_f32 v241, v241
    v_smfmac_f32_32x32x32_bf16 v[160:175], v[136:139], v[232:239], v14
    v_add_u32 v17, 0xe400, v17
    s_mov_b64 exec, s[46:47]
    ds_read_b128 v[132:135], v17 offset:0
    ds_read_b128 v[136:139], v17 offset:576
    s_mov_b64 exec, -1
    v_exp_f32 v242, v242
    v_exp_f32 v243, v243
    v_exp_f32 v244, v244
    v_exp_f32 v245, v245
    s_waitcnt lgkmcnt(6)
    v_mfma_f32_32x32x16_bf16 v[192:207], v[148:151], v[2:5], v[192:207]
    ds_read_b32 v156, v16 offset:9728
    ds_read_b64 v[148:149], v15 offset:9728
    ds_read_b64 v[150:151], v15 offset:10240
    v_exp_f32 v246, v246
    v_exp_f32 v247, v247
    v_exp_f32 v248, v248
    v_exp_f32 v249, v249
    s_waitcnt lgkmcnt(5)
    v_smfmac_f32_32x32x32_bf16 v[160:175], v[140:143], v[240:247], v14
    v_exp_f32 v250, v250
    v_exp_f32 v251, v251
    v_exp_f32 v252, v252
    v_exp_f32 v253, v253
    v_mfma_f32_32x32x16_bf16 v[208:223], v[152:155], v[2:5], v[208:223]
    ds_read_b64 v[152:153], v15 offset:9984
    ds_read_b64 v[154:155], v15 offset:10496
    v_exp_f32 v254, v254
    v_exp_f32 v255, v255
    v_exp_f32 v192, v192
    v_exp_f32 v193, v193
    v_smfmac_f32_32x32x32_bf16 v[160:175], v[144:147], v[248:255], v14
    s_mov_b64 exec, s[46:47]
    ds_read_b128 v[140:143], v17 offset:1152
    ds_read_b128 v[144:147], v17 offset:1728
    s_mov_b64 exec, -1
    v_exp_f32 v194, v194
    v_exp_f32 v195, v195
    v_exp_f32 v196, v196
    v_exp_f32 v197, v197
    s_waitcnt lgkmcnt(6)
    v_mfma_f32_32x32x4_2b_bf16 v[224:255], v[156:157], v[6:7], 0
    v_exp_f32 v198, v198
    v_exp_f32 v199, v199
    v_exp_f32 v200, v200
    v_exp_f32 v201, v201
    v_exp_f32 v202, v202
    v_exp_f32 v203, v203
    v_exp_f32 v204, v204
    v_exp_f32 v205, v205
    v_smfmac_f32_32x32x32_bf16 v[160:175], v[132:135], v[192:199], v14
    s_waitcnt vmcnt(0)
L_poll_14:
    v_cmp_ne_u32 vcc, s31, v39
    s_cbranch_vccnz L_poll_14_r
L_poll_14_k:
    s_add_u32 s60, s51, 3540992
    buffer_load_dwordx2 v[8:9], v22, s[20:23], s60 offen sc1
    buffer_load_dwordx2 v[10:11], v22, s[20:23], s60 offen offset:512 sc1
    buffer_load_dword v12, v23, s[20:23], s60 offen sc1
    s_add_u32 m0, s45, 77824
    s_add_u32 s50, s50, 1770496
    buffer_load_dwordx4 v18, s[20:23], s50 offen offset:0 sc1 lds
    buffer_load_dwordx4 v18, s[20:23], s50 offen offset:1024 sc1 lds
    v_exp_f32 v206, v206
    v_exp_f32 v207, v207
    v_exp_f32 v208, v208
    v_exp_f32 v209, v209
    v_smfmac_f32_32x32x32_bf16 v[160:175], v[136:139], v[200:207], v14
    s_mov_b64 exec, s[46:47]
    ds_read_b128 v[132:135], v17 offset:9728
    ds_read_b128 v[136:139], v17 offset:10304
    s_mov_b64 exec, -1
    s_setprio 0
    buffer_load_dwordx4 v19, s[20:23], s50 offen offset:2048 sc1 lds
    buffer_load_dwordx4 v20, s[20:23], s50 offen offset:3072 sc1 lds
    s_add_u32 m0, m0, 4096
    s_mov_b64 exec, s[48:49]
    buffer_load_dwordx4 v21, s[20:23], s50 offen sc1 lds
    s_mov_b64 exec, -1
    v_exp_f32 v210, v210
    v_exp_f32 v211, v211
    v_exp_f32 v212, v212
    v_exp_f32 v213, v213
    s_waitcnt lgkmcnt(6)
    v_mfma_f32_32x32x16_bf16 v[224:239], v[148:151], v[2:5], v[224:239]
    v_exp_f32 v214, v214
    v_exp_f32 v215, v215
    v_exp_f32 v216, v216
    v_exp_f32 v217, v217
    s_waitcnt lgkmcnt(2)
    v_smfmac_f32_32x32x32_bf16 v[160:175], v[140:143], v[208:215], v14
    v_exp_f32 v218, v218
    v_exp_f32 v219, v219
    v_exp_f32 v220, v220
    v_exp_f32 v221, v221
    v_mfma_f32_32x32x16_bf16 v[240:255], v[152:155], v[2:5], v[240:255]
    v_exp_f32 v222, v222
    v_exp_f32 v223, v223
    v_exp_f32 v224, v224
    v_exp_f32 v225, v225
    v_smfmac_f32_32x32x32_bf16 v[160:175], v[144:147], v[216:223], v14
    s_mov_b64 exec, s[46:47]
    ds_read_b128 v[140:143], v17 offset:10880
    ds_read_b128 v[144:147], v17 offset:11456
    s_mov_b64 exec, -1
    v_exp_f32 v226, v226
    v_exp_f32 v227, v227
    v_exp_f32 v228, v228
    v_exp_f32 v229, v229
    s_waitcnt vmcnt(5)
    v_mfma_f32_32x32x4_2b_bf16 v[192:223], v[156:157], v[12:13], 0
    v_exp_f32 v230, v230
    v_exp_f32 v231, v231
    v_exp_f32 v232, v232
    v_exp_f32 v233, v233
    v_exp_f32 v234, v234
    v_exp_f32 v235, v235
    v_exp_f32 v236, v236
    v_exp_f32 v237, v237
    s_waitcnt lgkmcnt(2)
    v_smfmac_f32_32x32x32_bf16 v[160:175], v[132:135], v[224:231], v14
    v_exp_f32 v238, v238
    v_exp_f32 v239, v239
    v_exp_f32 v240, v240
    v_exp_f32 v241, v241
    v_smfmac_f32_32x32x32_bf16 v[160:175], v[136:139], v[232:239], v14
    v_exp_f32 v242, v242
    v_exp_f32 v243, v243
    v_exp_f32 v244, v244
    v_exp_f32 v245, v245
    v_mfma_f32_32x32x16_bf16 v[192:207], v[148:151], v[8:11], v[192:207]
    ds_read_b32 v156, v16 offset:0
    ds_read_b64 v[148:149], v15 offset:0
    ds_read_b64 v[150:151], v15 offset:512
    v_exp_f32 v246, v246
    v_exp_f32 v247, v247
    v_exp_f32 v248, v248
    v_exp_f32 v249, v249
    s_waitcnt lgkmcnt(3)
    v_smfmac_f32_32x32x32_bf16 v[160:175], v[140:143], v[240:247], v14
    s_setprio 3
    v_exp_f32 v250, v250
    v_exp_f32 v251, v251
    v_exp_f32 v252, v252
    v_exp_f32 v253, v253
    v_mfma_f32_32x32x16_bf16 v[208:223], v[152:155], v[8:11], v[208:223]
    ds_read_b64 v[152:153], v15 offset:256
    ds_read_b64 v[154:155], v15 offset:768
    v_exp_f32 v254, v254
    v_exp_f32 v255, v255
    v_exp_f32 v192, v192
    v_exp_f32 v193, v193
    v_smfmac_f32_32x32x32_bf16 v[160:175], v[144:147], v[248:255], v14
    v_exp_f32 v194, v194
    v_exp_f32 v195, v195
    v_exp_f32 v196, v196
    v_exp_f32 v197, v197
    s_waitcnt lgkmcnt(4)
    v_mfma_f32_32x32x4_2b_bf16 v[224:255], v[156:157], v[12:13], 0
    v_exp_f32 v198, v198
    v_exp_f32 v199, v199
    v_exp_f32 v200, v200
    v_exp_f32 v201, v201
    v_exp_f32 v202, v202
    v_exp_f32 v203, v203
    v_exp_f32 v204, v204
    v_exp_f32 v205, v205
    v_smfmac_f32_32x32x32_bf16 v[176:191], v[132:135], v[192:199], v14
    s_waitcnt vmcnt(0)
    s_mov_b64 exec, 1
    ds_write_b32 v158, v0 offset:128
    s_mov_b64 exec, -1
    v_exp_f32 v206, v206
    v_exp_f32 v207, v207
    v_exp_f32 v208, v208
    v_exp_f32 v209, v209
    v_smfmac_f32_32x32x32_bf16 v[176:191], v[136:139], v[200:207], v14
    s_mov_b64 exec, s[46:47]
    ds_read_b128 v[132:135], v17 offset:0
    ds_read_b128 v[136:139], v17 offset:576
    s_mov_b64 exec, -1
    ds_read_b32 v24, v159 offset:128
    v_exp_f32 v210, v210
    v_exp_f32 v211, v211
    v_exp_f32 v212, v212
    v_exp_f32 v213, v213
    s_waitcnt lgkmcnt(6)
    v_mfma_f32_32x32x16_bf16 v[224:239], v[148:151], v[8:11], v[224:239]
    s_waitcnt lgkmcnt(0)
L_word_15:
    v_cmp_ne_u32 vcc, s31, v24
    s_cbranch_vccnz L_word_15_r
L_word_15_k:
    ds_read_b32 v156, v16 offset:19456
    ds_read_b64 v[148:149], v15 offset:19456
    ds_read_b64 v[150:151], v15 offset:19968
    v_exp_f32 v214, v214
    v_exp_f32 v215, v215
    v_exp_f32 v216, v216
    v_exp_f32 v217, v217
    v_smfmac_f32_32x32x32_bf16 v[176:191], v[140:143], v[208:215], v14
    s_add_u32 m0, s45, 116736
    s_add_u32 s50, s50, 1770496
    buffer_load_dwordx4 v18, s[20:23], s50 offen offset:0 sc1 lds
    v_exp_f32 v218, v218
    v_exp_f32 v219, v219
    v_exp_f32 v220, v220
    v_exp_f32 v221, v221
    v_mfma_f32_32x32x16_bf16 v[240:255], v[152:155], v[8:11], v[240:255]
    ds_read_b64 v[152:153], v15 offset:19712
    ds_read_b64 v[154:155], v15 offset:20224
    buffer_load_dwordx4 v18, s[20:23], s50 offen offset:1024 sc1 lds
    v_exp_f32 v222, v222
    v_exp_f32 v223, v223
    v_exp_f32 v224, v224
    v_exp_f32 v225, v225
    v_smfmac_f32_32x32x32_bf16 v[176:191], v[144:147], v[216:223], v14
    s_mov_b64 exec, s[46:47]
    ds_read_b128 v[140:143], v17 offset:1152
    ds_read_b128 v[144:147], v17 offset:1728
    s_mov_b64 exec, -1
    buffer_load_dwordx4 v19, s[20:23], s50 offen offset:2048 sc1 lds
    v_exp_f32 v226, v226
    v_exp_f32 v227, v227
    v_exp_f32 v228, v228
    v_exp_f32 v229, v229
    s_waitcnt lgkmcnt(6)
    v_mfma_f32_32x32x4_2b_bf16 v[192:223], v[156:157], v[6:7], 0
    buffer_load_dwordx4 v20, s[20:23], s50 offen offset:3072 sc1 lds
    v_exp_f32 v230, v230
    v_exp_f32 v231, v231
    v_exp_f32 v232, v232
    v_exp_f32 v233, v233
    v_exp_f32 v234, v234
    v_exp_f32 v235, v235
    v_exp_f32 v236, v236
    v_exp_f32 v237, v237
    v_smfmac_f32_32x32x32_bf16 v[176:191], v[132:135], v[224:231], v14
    s_add_u32 m0, m0, 4096
    s_mov_b64 exec, s[48:49]
    buffer_load_dwordx4 v21, s[20:23], s50 offen sc1 lds
    s_mov_b64 exec, -1
    v_exp_f32 v238, v238
    v_exp_f32 v239, v239
    v_exp_f32 v240, v240
    v_exp_f32 v241, v241
    v_smfmac_f32_32x32x32_bf16 v[176:191], v[136:139], v[232:239], v14
    s_mov_b64 exec, s[46:47]
    ds_read_b128 v[132:135], v17 offset:19456
    ds_read_b128 v[136:139], v17 offset:20032
    s_mov_b64 exec, -1
    v_exp_f32 v242, v242
    v_exp_f32 v243, v243
    v_exp_f32 v244, v244
    v_exp_f32 v245, v245
    s_waitcnt lgkmcnt(6)
    v_mfma_f32_32x32x16_bf16 v[192:207], v[148:151], v[2:5], v[192:207]
    v_exp_f32 v246, v246
    v_exp_f32 v247, v247
    v_exp_f32 v248, v248
    v_exp_f32 v249, v249
    s_waitcnt lgkmcnt(2)
    v_smfmac_f32_32x32x32_bf16 v[176:191], v[140:143], v[240:247], v14
    v_exp_f32 v250, v250
    v_exp_f32 v251, v251
    v_exp_f32 v252, v252
    v_exp_f32 v253, v253
    v_mfma_f32_32x32x16_bf16 v[208:223], v[152:155], v[2:5], v[208:223]
    v_exp_f32 v254, v254
    v_exp_f32 v255, v255
    v_exp_f32 v192, v192
    v_exp_f32 v193, v193
    v_smfmac_f32_32x32x32_bf16 v[176:191], v[144:147], v[248:255], v14
    s_mov_b64 exec, s[46:47]
    ds_read_b128 v[140:143], v17 offset:20608
    ds_read_b128 v[144:147], v17 offset:21184
    s_mov_b64 exec, -1
    v_exp_f32 v194, v194
    v_exp_f32 v195, v195
    v_exp_f32 v196, v196
    v_exp_f32 v197, v197
    v_mfma_f32_32x32x4_2b_bf16 v[224:255], v[156:157], v[12:13], 0
    v_exp_f32 v198, v198
    v_exp_f32 v199, v199
    v_exp_f32 v200, v200
    v_exp_f32 v201, v201
    v_exp_f32 v202, v202
    v_exp_f32 v203, v203
    v_exp_f32 v204, v204
    v_exp_f32 v205, v205
    s_waitcnt lgkmcnt(2)
    v_smfmac_f32_32x32x32_bf16 v[160:175], v[132:135], v[192:199], v14
    v_exp_f32 v206, v206
    v_exp_f32 v207, v207
    v_exp_f32 v208, v208
    v_exp_f32 v209, v209
    v_smfmac_f32_32x32x32_bf16 v[160:175], v[136:139], v[200:207], v14
    v_exp_f32 v210, v210
    v_exp_f32 v211, v211
    v_exp_f32 v212, v212
    v_exp_f32 v213, v213
    v_mfma_f32_32x32x16_bf16 v[224:239], v[148:151], v[8:11], v[224:239]
    ds_read_b32 v156, v16 offset:29184
    ds_read_b64 v[148:149], v15 offset:29184
    ds_read_b64 v[150:151], v15 offset:29696
    v_exp_f32 v214, v214
    v_exp_f32 v215, v215
    v_exp_f32 v216, v216
    v_exp_f32 v217, v217
    s_waitcnt lgkmcnt(3)
    v_smfmac_f32_32x32x32_bf16 v[160:175], v[140:143], v[208:215], v14
    v_exp_f32 v218, v218
    v_exp_f32 v219, v219
    v_exp_f32 v220, v220
    v_exp_f32 v221, v221
    v_mfma_f32_32x32x16_bf16 v[240:255], v[152:155], v[8:11], v[240:255]
    ds_read_b64 v[152:153], v15 offset:29440
    ds_read_b64 v[154:155], v15 offset:29952
    v_exp_f32 v222, v222
    v_exp_f32 v223, v223
    v_exp_f32 v224, v224
    v_exp_f32 v225, v225
    v_smfmac_f32_32x32x32_bf16 v[160:175], v[144:147], v[216:223], v14
    v_exp_f32 v226, v226
    v_exp_f32 v227, v227
    v_exp_f32 v228, v228
    v_exp_f32 v229, v229
    s_waitcnt lgkmcnt(4)
    v_mfma_f32_32x32x4_2b_bf16 v[192:223], v[156:157], v[6:7], 0
    v_exp_f32 v230, v230
    v_exp_f32 v231, v231
    v_exp_f32 v232, v232
    v_exp_f32 v233, v233
    v_exp_f32 v234, v234
    v_exp_f32 v235, v235
    v_exp_f32 v236, v236
    v_exp_f32 v237, v237
    v_smfmac_f32_32x32x32_bf16 v[176:191], v[132:135], v[224:231], v14
    buffer_load_dword v39, v36, s[20:23], 0 offen offset:0 sc1
    v_exp_f32 v238, v238
    v_exp_f32 v239, v239
    v_exp_f32 v240, v240
    v_exp_f32 v241, v241
    v_smfmac_f32_32x32x32_bf16 v[176:191], v[136:139], v[232:239], v14
    s_mov_b64 exec, s[46:47]
    ds_read_b128 v[132:135], v17 offset:29184
    ds_read_b128 v[136:139], v17 offset:29760
    s_mov_b64 exec, -1
    v_exp_f32 v242, v242
    v_exp_f32 v243, v243
    v_exp_f32 v244, v244
    v_exp_f32 v245, v245
    s_waitcnt lgkmcnt(4)
    v_mfma_f32_32x32x16_bf16 v[192:207], v[148:151], v[2:5], v[192:207]
    v_exp_f32 v246, v246
    v_exp_f32 v247, v247
    v_exp_f32 v248, v248
    v_exp_f32 v249, v249
    v_smfmac_f32_32x32x32_bf16 v[176:191], v[140:143], v[240:247], v14
    v_exp_f32 v250, v250
    v_exp_f32 v251, v251
    v_exp_f32 v252, v252
    v_exp_f32 v253, v253
    s_waitcnt lgkmcnt(2)
    v_mfma_f32_32x32x16_bf16 v[208:223], v[152:155], v[2:5], v[208:223]
    v_exp_f32 v254, v254
    v_exp_f32 v255, v255
    v_exp_f32 v192, v192
    v_exp_f32 v193, v193
    v_smfmac_f32_32x32x32_bf16 v[176:191], v[144:147], v[248:255], v14
    s_mov_b64 exec, s[46:47]
    ds_read_b128 v[140:143], v17 offset:30336
    ds_read_b128 v[144:147], v17 offset:30912
    s_mov_b64 exec, -1
    v_exp_f32 v194, v194
    v_exp_f32 v195, v195
    v_exp_f32 v196, v196
    v_exp_f32 v197, v197
    v_mfma_f32_32x32x4_2b_bf16 v[224:255], v[156:157], v[12:13], 0
    v_exp_f32 v198, v198
    v_exp_f32 v199, v199
    v_exp_f32 v200, v200
    v_exp_f32 v201, v201
    v_exp_f32 v202, v202
    v_exp_f32 v203, v203
    v_exp_f32 v204, v204
    v_exp_f32 v205, v205
    s_waitcnt lgkmcnt(2)
    v_smfmac_f32_32x32x32_bf16 v[160:175], v[132:135], v[192:199], v14
    v_exp_f32 v206, v206
    v_exp_f32 v207, v207
    v_exp_f32 v208, v208
    v_exp_f32 v209, v209
    v_smfmac_f32_32x32x32_bf16 v[160:175], v[136:139], v[200:207], v14
    v_exp_f32 v210, v210
    v_exp_f32 v211, v211
L_pad1:
    s_cbranch_execz L_warm_ret
    v_exp_f32 v212, v212
    v_exp_f32 v213, v213
    v_mfma_f32_32x32x16_bf16 v[224:239], v[148:151], v[8:11], v[224:239]
    ds_read_b32 v156, v16 offset:38912
    ds_read_b64 v[148:149], v15 offset:38912
    ds_read_b64 v[150:151], v15 offset:39424
    v_exp_f32 v214, v214
    v_exp_f32 v215, v215
    v_exp_f32 v216, v216
    v_exp_f32 v217, v217
    s_waitcnt lgkmcnt(3)
    v_smfmac_f32_32x32x32_bf16 v[160:175], v[140:143], v[208:215], v14
    v_exp_f32 v218, v218
    v_exp_f32 v219, v219
    v_exp_f32 v220, v220
    v_exp_f32 v221, v221
    v_mfma_f32_32x32x16_bf16 v[240:255], v[152:155], v[8:11], v[240:255]
    ds_read_b64 v[152:153], v15 offset:39168
    ds_read_b64 v[154:155], v15 offset:39680
    v_exp_f32 v222, v222
    v_exp_f32 v223, v223
    v_exp_f32 v224, v224
    v_exp_f32 v225, v225
    v_smfmac_f32_32x32x32_bf16 v[160:175], v[144:147], v[216:223], v14
    v_exp_f32 v226, v226
    v_exp_f32 v227, v227
    v_exp_f32 v228, v228
    v_exp_f32 v229, v229
    s_waitcnt lgkmcnt(4)
    v_mfma_f32_32x32x4_2b_bf16 v[192:223], v[156:157], v[6:7], 0
    v_exp_f32 v230, v230
    v_exp_f32 v231, v231
    v_exp_f32 v232, v232
    v_exp_f32 v233, v233
    v_exp_f32 v234, v234
    v_exp_f32 v235, v235
    v_exp_f32 v236, v236
    v_exp_f32 v237, v237
    v_smfmac_f32_32x32x32_bf16 v[176:191], v[132:135], v[224:231], v14
    s_waitcnt vmcnt(1)
    s_mov_b64 exec, 1
    ds_write_b32 v158, v0 offset:192
    s_mov_b64 exec, -1
    v_xor_b32 v18, 0x100, v28
    v_xor_b32 v19, 64, v29
    s_add_u32 s35, s12, 1183744
    s_add_u32 s36, s13, 1183744
    s_add_u32 s37, s14, 1183744
    s_add_u32 s75, s75, 1179648
    v_exp_f32 v238, v238
    v_exp_f32 v239, v239
    v_exp_f32 v240, v240
    v_exp_f32 v241, v241
    v_smfmac_f32_32x32x32_bf16 v[176:191], v[136:139], v[232:239], v14
    s_mov_b64 exec, s[46:47]
    ds_read_b128 v[132:135], v17 offset:38912
    ds_read_b128 v[136:139], v17 offset:39488
    s_mov_b64 exec, -1
    s_waitcnt vmcnt(0)
L_poll_16:
    v_cmp_ne_u32 vcc, s31, v39
    s_cbranch_vccnz L_poll_16_r
L_poll_16_k:
    v_exp_f32 v242, v242
    v_exp_f32 v243, v243
    v_exp_f32 v244, v244
    v_exp_f32 v245, v245
    s_waitcnt lgkmcnt(5)
    v_mfma_f32_32x32x16_bf16 v[192:207], v[148:151], v[2:5], v[192:207]
    v_exp_f32 v246, v246
    v_exp_f32 v247, v247
    v_exp_f32 v248, v248
    v_exp_f32 v249, v249
    v_smfmac_f32_32x32x32_bf16 v[176:191], v[140:143], v[240:247], v14
    v_exp_f32 v250, v250
    v_exp_f32 v251, v251
    v_exp_f32 v252, v252
    v_exp_f32 v253, v253
    s_waitcnt lgkmcnt(3)
    v_mfma_f32_32x32x16_bf16 v[208:223], v[152:155], v[2:5], v[208:223]
    v_exp_f32 v254, v254
    v_exp_f32 v255, v255
    v_exp_f32 v192, v192
    v_exp_f32 v193, v193
    v_smfmac_f32_32x32x32_bf16 v[176:191], v[144:147], v[248:255], v14
    s_mov_b64 exec, s[46:47]
    ds_read_b128 v[140:143], v17 offset:40064
    ds_read_b128 v[144:147], v17 offset:40640
    s_mov_b64 exec, -1
    v_exp_f32 v194, v194
    v_exp_f32 v195, v195
    v_exp_f32 v196, v196
    v_exp_f32 v197, v197
    v_mfma_f32_32x32x4_2b_bf16 v[224:255], v[156:157], v[12:13], 0
    v_exp_f32 v198, v198
    v_exp_f32 v199, v199
    v_exp_f32 v200, v200
    v_exp_f32 v201, v201
    v_exp_f32 v202, v202
    v_exp_f32 v203, v203
    v_exp_f32 v204, v204
    v_exp_f32 v205, v205
    s_waitcnt lgkmcnt(2)
    v_smfmac_f32_32x32x32_bf16 v[160:175], v[132:135], v[192:199], v14
    buffer_load_dwordx4 v[42:45], v40, s[20:23], s70 offen offset:0 sc1
    v_exp_f32 v206, v206
    v_exp_f32 v207, v207
    v_exp_f32 v208, v208
    v_exp_f32 v209, v209
    v_smfmac_f32_32x32x32_bf16 v[160:175], v[136:139], v[200:207], v14
    buffer_load_dwordx4 v[46:49], v40, s[20:23], s70 offen offset:1024 sc1
    v_exp_f32 v210, v210
    v_exp_f32 v211, v211
    v_exp_f32 v212, v212
    v_exp_f32 v213, v213
    v_mfma_f32_32x32x16_bf16 v[224:239], v[148:151], v[8:11], v[224:239]
    ds_read_b32 v156, v16 offset:48640
    ds_read_b64 v[148:149], v15 offset:48640
    ds_read_b64 v[150:151], v15 offset:49152
    v_exp_f32 v214, v214
    v_exp_f32 v215, v215
    v_exp_f32 v216, v216
    v_exp_f32 v217, v217
    s_waitcnt lgkmcnt(3)
    v_smfmac_f32_32x32x32_bf16 v[160:175], v[140:143], v[208:215], v14
    buffer_load_dwordx4 v[50:53], v40, s[20:23], s70 offen offset:2048 sc1
    v_exp_f32 v218, v218
    v_exp_f32 v219, v219
    v_exp_f32 v220, v220
    v_exp_f32 v221, v221
    v_mfma_f32_32x32x16_bf16 v[240:255], v[152:155], v[8:11], v[240:255]
    ds_read_b64 v[152:153], v15 offset:48896
    ds_read_b64 v[154:155], v15 offset:49408
    v_exp_f32 v222, v222
    v_exp_f32 v223, v223
    v_exp_f32 v224, v224
    v_exp_f32 v225, v225
    v_smfmac_f32_32x32x32_bf16 v[160:175], v[144:147], v[216:223], v14
    v_exp_f32 v226, v226
    v_exp_f32 v227, v227
    v_exp_f32 v228, v228
    v_exp_f32 v229, v229
    s_waitcnt lgkmcnt(4)
    v_mfma_f32_32x32x4_2b_bf16 v[192:223], v[156:157], v[6:7], 0
    v_exp_f32 v230, v230
    v_exp_f32 v231, v231
    v_exp_f32 v232, v232
    v_exp_f32 v233, v233
    v_exp_f32 v234, v234
    v_exp_f32 v235, v235
    v_exp_f32 v236, v236
    v_exp_f32 v237, v237
    v_smfmac_f32_32x32x32_bf16 v[176:191], v[132:135], v[224:231], v14
    buffer_load_dwordx4 v[54:57], v40, s[20:23], s70 offen offset:3072 sc1
    v_exp_f32 v238, v238
    v_exp_f32 v239, v239
    v_exp_f32 v240, v240
    v_exp_f32 v241, v241
    v_smfmac_f32_32x32x32_bf16 v[176:191], v[136:139], v[232:239], v14
    s_mov_b64 exec, s[46:47]
    ds_read_b128 v[132:135], v17 offset:48640
    ds_read_b128 v[136:139], v17 offset:49216
    s_mov_b64 exec, -1
    buffer_load_dwordx2 v[58:59], v41, s[20:23], s70 offen sc1
    v_exp_f32 v242, v242
    v_exp_f32 v243, v243
    v_exp_f32 v244, v244
    v_exp_f32 v245, v245
    s_waitcnt lgkmcnt(4)
    v_mfma_f32_32x32x16_bf16 v[192:207], v[148:151], v[2:5], v[192:207]
    v_exp_f32 v246, v246
    v_exp_f32 v247, v247
    v_exp_f32 v248, v248
    v_exp_f32 v249, v249
    v_smfmac_f32_32x32x32_bf16 v[176:191], v[140:143], v[240:247], v14
    buffer_load_dwordx4 v[60:63], v40, s[20:23], s71 offen offset:0 sc1
    v_exp_f32 v250, v250
    v_exp_f32 v251, v251
    v_exp_f32 v252, v252
    v_exp_f32 v253, v253
    s_waitcnt lgkmcnt(2)
    v_mfma_f32_32x32x16_bf16 v[208:223], v[152:155], v[2:5], v[208:223]
    v_exp_f32 v254, v254
    v_exp_f32 v255, v255
    v_exp_f32 v192, v192
    v_exp_f32 v193, v193
    v_smfmac_f32_32x32x32_bf16 v[176:191], v[144:147], v[248:255], v14
    s_mov_b64 exec, s[46:47]
    ds_read_b128 v[140:143], v17 offset:49792
    ds_read_b128 v[144:147], v17 offset:50368
    s_mov_b64 exec, -1
    v_exp_f32 v194, v194
    v_exp_f32 v195, v195
    v_exp_f32 v196, v196
    v_exp_f32 v197, v197
    v_mfma_f32_32x32x4_2b_bf16 v[224:255], v[156:157], v[12:13], 0
    v_exp_f32 v198, v198
    v_exp_f32 v199, v199
    v_exp_f32 v200, v200
    v_exp_f32 v201, v201
    v_exp_f32 v202, v202
    v_exp_f32 v203, v203
    v_exp_f32 v204, v204
    v_exp_f32 v205, v205
    s_waitcnt lgkmcnt(2)
    v_smfmac_f32_32x32x32_bf16 v[160:175], v[132:135], v[192:199], v14
    buffer_load_dwordx4 v[64:67], v40, s[20:23], s71 offen offset:1024 sc1
    v_exp_f32 v206, v206
    v_exp_f32 v207, v207
    v_exp_f32 v208, v208
    v_exp_f32 v209, v209
    v_smfmac_f32_32x32x32_bf16 v[160:175], v[136:139], v[200:207], v14
    ds_read_b32 v24, v159 offset:192
    buffer_load_dwordx4 v[68:71], v40, s[20:23], s71 offen offset:2048 sc1
    v_exp_f32 v210, v210
    v_exp_f32 v211, v211
    v_exp_f32 v212, v212
    v_exp_f32 v213, v213
    v_mfma_f32_32x32x16_bf16 v[224:239], v[148:151], v[8:11], v[224:239]
    s_waitcnt lgkmcnt(0)
L_word_17:
    v_cmp_ne_u32 vcc, s31, v24
    s_cbranch_vccnz L_word_17_r
L_word_17_k:
    v_add_u32 v16, 0xe400, v16
    ds_read_b32 v156, v16 offset:0
    v_add_u32 v15, 0xe400, v15
    ds_read_b64 v[148:149], v15 offset:0
    ds_read_b64 v[150:151], v15 offset:512
    v_exp_f32 v214, v214
    v_exp_f32 v215, v215
    v_exp_f32 v216, v216
    v_exp_f32 v217, v217
    v_smfmac_f32_32x32x32_bf16 v[160:175], v[140:143], v[208:215], v14
    buffer_load_dwordx4 v[72:75], v40, s[20:23], s71 offen offset:3072 sc1
    v_exp_f32 v218, v218
    v_exp_f32 v219, v219
    v_exp_f32 v220, v220
    v_exp_f32 v221, v221
    v_mfma_f32_32x32x16_bf16 v[240:255], v[152:155], v[8:11], v[240:255]
    ds_read_b64 v[152:153], v15 offset:256
    ds_read_b64 v[154:155], v15 offset:768
    v_exp_f32 v222, v222
    v_exp_f32 v223, v223
    v_exp_f32 v224, v224
    v_exp_f32 v225, v225
    v_smfmac_f32_32x32x32_bf16 v[160:175], v[144:147], v[216:223], v14
    v_exp_f32 v226, v226
    v_exp_f32 v227, v227
    v_exp_f32 v228, v228
    v_exp_f32 v229, v229
    s_waitcnt lgkmcnt(4)
    v_mfma_f32_32x32x4_2b_bf16 v[192:223], v[156:157], v[6:7], 0
    v_exp_f32 v230, v230
    v_exp_f32 v231, v231
    v_exp_f32 v232, v232
    v_exp_f32 v233, v233
    v_exp_f32 v234, v234
    v_exp_f32 v235, v235
    v_exp_f32 v236, v236
    v_exp_f32 v237, v237
    v_smfmac_f32_32x32x32_bf16 v[176:191], v[132:135], v[224:231], v14
    buffer_load_dwordx2 v[76:77], v41, s[20:23], s71 offen sc1
    v_exp_f32 v238, v238
    v_exp_f32 v239, v239
    v_exp_f32 v240, v240
    v_exp_f32 v241, v241
    v_smfmac_f32_32x32x32_bf16 v[176:191], v[136:139], v[232:239], v14
    v_add_u32 v17, 0xe400, v17
    s_mov_b64 exec, s[46:47]
    ds_read_b128 v[132:135], v17 offset:0
    ds_read_b128 v[136:139], v17 offset:576
    s_mov_b64 exec, -1
    buffer_load_dwordx4 v[78:81], v40, s[20:23], s72 offen offset:0 sc1
    v_exp_f32 v242, v242
    v_exp_f32 v243, v243
    v_exp_f32 v244, v244
    v_exp_f32 v245, v245
    s_waitcnt lgkmcnt(4)
    v_mfma_f32_32x32x16_bf16 v[192:207], v[148:151], v[2:5], v[192:207]
    v_exp_f32 v246, v246
    v_exp_f32 v247, v247
    v_exp_f32 v248, v248
    v_exp_f32 v249, v249
    v_smfmac_f32_32x32x32_bf16 v[176:191], v[140:143], v[240:247], v14
    buffer_load_dwordx4 v[82:85], v40, s[20:23], s72 offen offset:1024 sc1
    v_exp_f32 v250, v250
    v_exp_f32 v251, v251
    v_exp_f32 v252, v252
    v_exp_f32 v253, v253
    s_waitcnt lgkmcnt(2)
    v_mfma_f32_32x32x16_bf16 v[208:223], v[152:155], v[2:5], v[208:223]
    v_exp_f32 v254, v254
    v_exp_f32 v255, v255
    v_exp_f32 v192, v192
    v_exp_f32 v193, v193
    v_smfmac_f32_32x32x32_bf16 v[176:191], v[144:147], v[248:255], v14
    s_mov_b64 exec, s[46:47]
    ds_read_b128 v[140:143], v17 offset:1152
    ds_read_b128 v[144:147], v17 offset:1728
    s_mov_b64 exec, -1
    v_exp_f32 v194, v194
    v_exp_f32 v195, v195
    v_exp_f32 v196, v196
    v_exp_f32 v197, v197
    v_mfma_f32_32x32x4_2b_bf16 v[224:255], v[156:157], v[12:13], 0
    v_exp_f32 v198, v198
    v_exp_f32 v199, v199
    v_exp_f32 v200, v200
    v_exp_f32 v201, v201
    v_exp_f32 v202, v202
    v_exp_f32 v203, v203
    v_exp_f32 v204, v204
    v_exp_f32 v205, v205
    s_waitcnt lgkmcnt(2)
    v_smfmac_f32_32x32x32_bf16 v[160:175], v[132:135], v[192:199], v14
    buffer_load_dwordx4 v[86:89], v40, s[20:23], s72 offen offset:2048 sc1
    v_exp_f32 v206, v206
    v_exp_f32 v207, v207
    v_exp_f32 v208, v208
    v_exp_f32 v209, v209
    v_smfmac_f32_32x32x32_bf16 v[160:175], v[136:139], v[200:207], v14
    buffer_load_dwordx4 v[90:93], v40, s[20:23], s72 offen offset:3072 sc1
    v_exp_f32 v210, v210
    v_exp_f32 v211, v211
    v_exp_f32 v212, v212
    v_exp_f32 v213, v213
    v_mfma_f32_32x32x16_bf16 v[224:239], v[148:151], v[8:11], v[224:239]
    ds_read_b32 v156, v16 offset:9728
    ds_read_b64 v[148:149], v15 offset:9728
    ds_read_b64 v[150:151], v15 offset:10240
    v_exp_f32 v214, v214
    v_exp_f32 v215, v215
    v_exp_f32 v216, v216
    v_exp_f32 v217, v217
    s_waitcnt lgkmcnt(3)
    v_smfmac_f32_32x32x32_bf16 v[160:175], v[140:143], v[208:215], v14
    buffer_load_dwordx2 v[94:95], v41, s[20:23], s72 offen sc1
    v_exp_f32 v218, v218
    v_exp_f32 v219, v219
    v_exp_f32 v220, v220
    v_exp_f32 v221, v221
    v_mfma_f32_32x32x16_bf16 v[240:255], v[152:155], v[8:11], v[240:255]
    ds_read_b64 v[152:153], v15 offset:9984
    ds_read_b64 v[154:155], v15 offset:10496
    v_exp_f32 v222, v222
    v_exp_f32 v223, v223
    v_exp_f32 v224, v224
    v_exp_f32 v225, v225
    v_smfmac_f32_32x32x32_bf16 v[160:175], v[144:147], v[216:223], v14
    v_exp_f32 v226, v226
    v_exp_f32 v227, v227
    v_exp_f32 v228, v228
    v_exp_f32 v229, v229
    s_waitcnt lgkmcnt(4)
    v_mfma_f32_32x32x4_2b_bf16 v[192:223], v[156:157], v[6:7], 0
    v_exp_f32 v230, v230
    v_exp_f32 v231, v231
    v_exp_f32 v232, v232
    v_exp_f32 v233, v233
    v_exp_f32 v234, v234
    v_exp_f32 v235, v235
    v_exp_f32 v236, v236
    v_exp_f32 v237, v237
    v_smfmac_f32_32x32x32_bf16 v[176:191], v[132:135], v[224:231], v14
    buffer_load_dwordx4 v[96:99], v40, s[20:23], s73 offen offset:0 sc1
    v_exp_f32 v238, v238
    v_exp_f32 v239, v239
    v_exp_f32 v240, v240
    v_exp_f32 v241, v241
    v_smfmac_f32_32x32x32_bf16 v[176:191], v[136:139], v[232:239], v14
    s_mov_b64 exec, s[46:47]
    ds_read_b128 v[132:135], v17 offset:9728
    ds_read_b128 v[136:139], v17 offset:10304
    s_mov_b64 exec, -1
    buffer_load_dwordx4 v[100:103], v40, s[20:23], s73 offen offset:1024 sc1
    v_exp_f32 v242, v242
    v_exp_f32 v243, v243
    v_exp_f32 v244, v244
    v_exp_f32 v245, v245
    s_waitcnt lgkmcnt(4)
    v_mfma_f32_32x32x16_bf16 v[192:207], v[148:151], v[2:5], v[192:207]
    v_exp_f32 v246, v246
    v_exp_f32 v247, v247
    v_exp_f32 v248, v248
    v_exp_f32 v249, v249
    v_smfmac_f32_32x32x32_bf16 v[176:191], v[140:143], v[240:247], v14
    buffer_load_dwordx4 v[104:107], v40, s[20:23], s73 offen offset:2048 sc1
    v_exp_f32 v250, v250
    v_exp_f32 v251, v251
    v_exp_f32 v252, v252
    v_exp_f32 v253, v253
    s_waitcnt lgkmcnt(2)
    v_mfma_f32_32x32x16_bf16 v[208:223], v[152:155], v[2:5], v[208:223]
    v_exp_f32 v254, v254
    v_exp_f32 v255, v255
    v_exp_f32 v192, v192
    v_exp_f32 v193, v193
    v_smfmac_f32_32x32x32_bf16 v[176:191], v[144:147], v[248:255], v14
    s_mov_b64 exec, s[46:47]
    ds_read_b128 v[140:143], v17 offset:10880
    ds_read_b128 v[144:147], v17 offset:11456
    s_mov_b64 exec, -1
    v_exp_f32 v194, v194
    v_exp_f32 v195, v195
    v_exp_f32 v196, v196
    v_exp_f32 v197, v197
    v_mfma_f32_32x32x4_2b_bf16 v[224:255], v[156:157], v[12:13], 0
    v_exp_f32 v198, v198
    v_exp_f32 v199, v199
    v_exp_f32 v200, v200
    v_exp_f32 v201, v201
    v_exp_f32 v202, v202
    v_exp_f32 v203, v203
    v_exp_f32 v204, v204
    v_exp_f32 v205, v205
    s_waitcnt lgkmcnt(2)
    v_smfmac_f32_32x32x32_bf16 v[160:175], v[132:135], v[192:199], v14
    buffer_load_dwordx4 v[108:111], v40, s[20:23], s73 offen offset:3072 sc1
    v_exp_f32 v206, v206
    v_exp_f32 v207, v207
    v_exp_f32 v208, v208
    v_exp_f32 v209, v209
    v_smfmac_f32_32x32x32_bf16 v[160:175], v[136:139], v[200:207], v14
    buffer_load_dwordx2 v[112:113], v41, s[20:23], s73 offen sc1
    v_exp_f32 v210, v210
    v_exp_f32 v211, v211
    v_exp_f32 v212, v212
    v_exp_f32 v213, v213
    v_mfma_f32_32x32x16_bf16 v[224:239], v[148:151], v[8:11], v[224:239]
    ds_read_b32 v156, v16 offset:19456
    ds_read_b64 v[148:149], v15 offset:19456
    ds_read_b64 v[150:151], v15 offset:19968
    v_exp_f32 v214, v214
    v_exp_f32 v215, v215
    v_exp_f32 v216, v216
    v_exp_f32 v217, v217
    s_waitcnt lgkmcnt(3)
    v_smfmac_f32_32x32x32_bf16 v[160:175], v[140:143], v[208:215], v14
    buffer_load_dwordx4 v[114:117], v40, s[20:23], s74 offen offset:0 sc1
    v_exp_f32 v218, v218
    v_exp_f32 v219, v219
    v_exp_f32 v220, v220
    v_exp_f32 v221, v221
    v_mfma_f32_32x32x16_bf16 v[240:255], v[152:155], v[8:11], v[240:255]
    ds_read_b64 v[152:153], v15 offset:19712
    ds_read_b64 v[154:155], v15 offset:20224
    v_exp_f32 v222, v222
    v_exp_f32 v223, v223
    v_exp_f32 v224, v224
    v_exp_f32 v225, v225
    v_smfmac_f32_32x32x32_bf16 v[160:175], v[144:147], v[216:223], v14
    v_exp_f32 v226, v226
    v_exp_f32 v227, v227
    v_exp_f32 v228, v228
    v_exp_f32 v229, v229
    s_waitcnt lgkmcnt(4)
    v_mfma_f32_32x32x4_2b_bf16 v[192:223], v[156:157], v[6:7], 0
    v_exp_f32 v230, v230
    v_exp_f32 v231, v231
    v_exp_f32 v232, v232
    v_exp_f32 v233, v233
    v_exp_f32 v234, v234
    v_exp_f32 v235, v235
    v_exp_f32 v236, v236
    v_exp_f32 v237, v237
    v_smfmac_f32_32x32x32_bf16 v[176:191], v[132:135], v[224:231], v14
    buffer_load_dwordx4 v[118:121], v40, s[20:23], s74 offen offset:1024 sc1
    v_exp_f32 v238, v238
    v_exp_f32 v239, v239
    v_exp_f32 v240, v240
    v_exp_f32 v241, v241
    v_smfmac_f32_32x32x32_bf16 v[176:191], v[136:139], v[232:239], v14
    s_mov_b64 exec, s[46:47]
    ds_read_b128 v[132:135], v17 offset:19456
    ds_read_b128 v[136:139], v17 offset:20032
    s_mov_b64 exec, -1
    buffer_load_dwordx4 v[122:125], v40, s[20:23], s74 offen offset:2048 sc1
    v_exp_f32 v242, v242
    v_exp_f32 v243, v243
    v_exp_f32 v244, v244
    v_exp_f32 v245, v245
    s_waitcnt lgkmcnt(4)
    v_mfma_f32_32x32x16_bf16 v[192:207], v[148:151], v[2:5], v[192:207]
    v_exp_f32 v246, v246
    v_exp_f32 v247, v247
    v_exp_f32 v248, v248
    v_exp_f32 v249, v249
    v_smfmac_f32_32x32x32_bf16 v[176:191], v[140:143], v[240:247], v14
    buffer_load_dwordx4 v[126:129], v40, s[20:23], s74 offen offset:3072 sc1
    v_exp_f32 v250, v250
    v_exp_f32 v251, v251
    v_exp_f32 v252, v252
    v_exp_f32 v253, v253
    s_waitcnt lgkmcnt(2)
    v_mfma_f32_32x32x16_bf16 v[208:223], v[152:155], v[2:5], v[208:223]
    v_exp_f32 v254, v254
    v_exp_f32 v255, v255
    v_exp_f32 v192, v192
    v_exp_f32 v193, v193
    v_smfmac_f32_32x32x32_bf16 v[176:191], v[144:147], v[248:255], v14
    s_mov_b64 exec, s[46:47]
    ds_read_b128 v[140:143], v17 offset:20608
    ds_read_b128 v[144:147], v17 offset:21184
    s_mov_b64 exec, -1
    s_setprio 2
    v_exp_f32 v194, v194
    v_exp_f32 v195, v195
    v_exp_f32 v196, v196
    v_exp_f32 v197, v197
    v_mfma_f32_32x32x4_2b_bf16 v[224:255], v[156:157], v[12:13], 0
    v_exp_f32 v198, v198
    v_exp_f32 v199, v199
    v_exp_f32 v200, v200
    v_exp_f32 v201, v201
    v_exp_f32 v202, v202
    v_exp_f32 v203, v203
    v_exp_f32 v204, v204
    v_exp_f32 v205, v205
    s_waitcnt lgkmcnt(2)
    v_smfmac_f32_32x32x32_bf16 v[160:175], v[132:135], v[192:199], v14
    buffer_load_dwordx2 v[130:131], v41, s[20:23], s74 offen sc1
    v_exp_f32 v206, v206
    v_exp_f32 v207, v207
    v_exp_f32 v208, v208
    v_exp_f32 v209, v209
    v_smfmac_f32_32x32x32_bf16 v[160:175], v[136:139], v[200:207], v14
    v_exp_f32 v210, v210
    v_exp_f32 v211, v211
    v_exp_f32 v212, v212
    v_exp_f32 v213, v213
    v_mfma_f32_32x32x16_bf16 v[224:239], v[148:151], v[8:11], v[224:239]
    ds_read_b32 v156, v16 offset:29184
    ds_read_b64 v[148:149], v15 offset:29184
    ds_read_b64 v[150:151], v15 offset:29696
    v_exp_f32 v214, v214
    v_exp_f32 v215, v215
    v_exp_f32 v216, v216
    v_exp_f32 v217, v217
    s_waitcnt lgkmcnt(3)
    v_smfmac_f32_32x32x32_bf16 v[160:175], v[140:143], v[208:215], v14
    v_exp_f32 v218, v218
    v_exp_f32 v219, v219
    v_exp_f32 v220, v220
    v_exp_f32 v221, v221
    v_mfma_f32_32x32x16_bf16 v[240:255], v[152:155], v[8:11], v[240:255]
    ds_read_b64 v[152:153], v15 offset:29440
    ds_read_b64 v[154:155], v15 offset:29952
    v_exp_f32 v222, v222
    v_exp_f32 v223, v223
    v_exp_f32 v224, v224
    v_exp_f32 v225, v225
    v_smfmac_f32_32x32x32_bf16 v[160:175], v[144:147], v[216:223], v14
    v_exp_f32 v226, v226
    v_exp_f32 v227, v227
    v_exp_f32 v228, v228
    v_exp_f32 v229, v229
    s_waitcnt lgkmcnt(4)
    v_mfma_f32_32x32x4_2b_bf16 v[192:223], v[156:157], v[6:7], 0
    v_exp_f32 v230, v230
    v_exp_f32 v231, v231
    v_exp_f32 v232, v232
    v_exp_f32 v233, v233
    v_exp_f32 v234, v234
    v_exp_f32 v235, v235
    v_exp_f32 v236, v236
    v_exp_f32 v237, v237
    v_smfmac_f32_32x32x32_bf16 v[176:191], v[132:135], v[224:231], v14
    v_exp_f32 v238, v238
    v_exp_f32 v239, v239
    v_exp_f32 v240, v240
    v_exp_f32 v241, v241
    v_smfmac_f32_32x32x32_bf16 v[176:191], v[136:139], v[232:239], v14
    s_mov_b64 exec, s[46:47]
    ds_read_b128 v[132:135], v17 offset:29184
    ds_read_b128 v[136:139], v17 offset:29760
    s_mov_b64 exec, -1
    v_exp_f32 v242, v242
    v_exp_f32 v243, v243
    v_exp_f32 v244, v244
    v_exp_f32 v245, v245
    s_waitcnt lgkmcnt(4)
    v_mfma_f32_32x32x16_bf16 v[192:207], v[148:151], v[2:5], v[192:207]
    v_exp_f32 v246, v246
    v_exp_f32 v247, v247
    v_exp_f32 v248, v248
    v_exp_f32 v249, v249
    v_smfmac_f32_32x32x32_bf16 v[176:191], v[140:143], v[240:247], v14
    v_exp_f32 v250, v250
    v_exp_f32 v251, v251
    v_exp_f32 v252, v252
    v_exp_f32 v253, v253
    s_waitcnt lgkmcnt(2)
    v_mfma_f32_32x32x16_bf16 v[208:223], v[152:155], v[2:5], v[208:223]
    v_exp_f32 v254, v254
    v_exp_f32 v255, v255
    v_exp_f32 v192, v192
    v_exp_f32 v193, v193
    v_smfmac_f32_32x32x32_bf16 v[176:191], v[144:147], v[248:255], v14
    s_mov_b64 exec, s[46:47]
    ds_read_b128 v[140:143], v17 offset:30336
    ds_read_b128 v[144:147], v17 offset:30912
    s_mov_b64 exec, -1
    v_exp_f32 v194, v194
    v_exp_f32 v195, v195
    v_exp_f32 v196, v196
    v_exp_f32 v197, v197
    v_mfma_f32_32x32x4_2b_bf16 v[224:255], v[156:157], v[12:13], 0
    v_exp_f32 v198, v198
    v_exp_f32 v199, v199
    v_exp_f32 v200, v200
    v_exp_f32 v201, v201
    v_exp_f32 v202, v202
    v_exp_f32 v203, v203
    v_exp_f32 v204, v204
    v_exp_f32 v205, v205
    s_waitcnt lgkmcnt(2)
    v_smfmac_f32_32x32x32_bf16 v[160:175], v[132:135], v[192:199], v14
    v_exp_f32 v206, v206
    v_exp_f32 v207, v207
    v_exp_f32 v208, v208
    v_exp_f32 v209, v209
    v_smfmac_f32_32x32x32_bf16 v[160:175], v[136:139], v[200:207], v14
    v_exp_f32 v210, v210
    v_exp_f32 v211, v211
    v_exp_f32 v212, v212
    v_exp_f32 v213, v213
    v_mfma_f32_32x32x16_bf16 v[224:239], v[148:151], v[8:11], v[224:239]
    v_add_u32 v16, 0xfffe3800, v16
    ds_read_b32 v156, v16 offset:0
    v_add_u32 v15, 0xfffe3800, v15
    ds_read_b64 v[148:149], v15 offset:0
    ds_read_b64 v[150:151], v15 offset:512
    v_exp_f32 v214, v214
    v_exp_f32 v215, v215
    v_exp_f32 v216, v216
    v_exp_f32 v217, v217
    s_waitcnt lgkmcnt(3)
    v_smfmac_f32_32x32x32_bf16 v[160:175], v[140:143], v[208:215], v14
    v_exp_f32 v218, v218
    v_exp_f32 v219, v219
    v_exp_f32 v220, v220
    v_exp_f32 v221, v221
    v_mfma_f32_32x32x16_bf16 v[240:255], v[152:155], v[8:11], v[240:255]
    ds_read_b64 v[152:153], v15 offset:256
    ds_read_b64 v[154:155], v15 offset:768
    v_exp_f32 v222, v222
    v_exp_f32 v223, v223
    v_exp_f32 v224, v224
    v_exp_f32 v225, v225
    v_smfmac_f32_32x32x32_bf16 v[160:175], v[144:147], v[216:223], v14
    v_exp_f32 v226, v226
    v_exp_f32 v227, v227
    v_exp_f32 v228, v228
    v_exp_f32 v229, v229
    s_waitcnt lgkmcnt(4)
    v_mfma_f32_32x32x4_2b_bf16 v[192:223], v[156:157], v[12:13], 0
    v_exp_f32 v230, v230
    v_exp_f32 v231, v231
    v_exp_f32 v232, v232
    v_exp_f32 v233, v233
    v_exp_f32 v234, v234
    v_exp_f32 v235, v235
    v_exp_f32 v236, v236
    v_exp_f32 v237, v237
    v_smfmac_f32_32x32x32_bf16 v[176:191], v[132:135], v[224:231], v14
    v_exp_f32 v238, v238
    v_exp_f32 v239, v239
    v_exp_f32 v240, v240
    v_exp_f32 v241, v241
    v_smfmac_f32_32x32x32_bf16 v[176:191], v[136:139], v[232:239], v14
    v_add_u32 v17, 0xfffe3800, v17
    s_mov_b64 exec, s[46:47]
    ds_read_b128 v[132:135], v17 offset:0
    ds_read_b128 v[136:139], v17 offset:576
    s_mov_b64 exec, -1
    v_mov_b32 v171, s31
    ds_write_b128 v26, v[160:163] offset:0
    ds_write_b128 v26, v[164:167] offset:1024
    ds_write_b128 v27, v[168:171] offset:0
    v_subrev_u32 v26, 97280, v26
    s_mov_b64 exec, 1
    ds_write_b32 v158, v0 offset:256
    s_mov_b64 exec, -1
    v_exp_f32 v242, v242
    v_exp_f32 v243, v243
    v_exp_f32 v244, v244
    v_exp_f32 v245, v245
    s_waitcnt lgkmcnt(5)
    v_mfma_f32_32x32x16_bf16 v[192:207], v[148:151], v[8:11], v[192:207]
    ds_read_b32 v156, v16 offset:9728
    ds_read_b64 v[148:149], v15 offset:9728
    ds_read_b64 v[150:151], v15 offset:10240
    v_exp_f32 v246, v246
    v_exp_f32 v247, v247
    v_exp_f32 v248, v248
    v_exp_f32 v249, v249
    v_smfmac_f32_32x32x32_bf16 v[176:191], v[140:143], v[240:247], v14
    v_exp_f32 v250, v250
    v_exp_f32 v251, v251
    v_exp_f32 v252, v252
    v_exp_f32 v253, v253
    s_waitcnt lgkmcnt(6)
    v_mfma_f32_32x32x16_bf16 v[208:223], v[152:155], v[8:11], v[208:223]
    ds_read_b64 v[152:153], v15 offset:9984
    ds_read_b64 v[154:155], v15 offset:10496
    v_exp_f32 v254, v254
    v_exp_f32 v255, v255
    v_exp_f32 v192, v192
    v_exp_f32 v193, v193
    v_smfmac_f32_32x32x32_bf16 v[176:191], v[144:147], v[248:255], v14
    s_mov_b64 exec, s[46:47]
    ds_read_b128 v[140:143], v17 offset:1152
    ds_read_b128 v[144:147], v17 offset:1728
    s_mov_b64 exec, -1
    s_setprio 2
    v_exp_f32 v194, v194
    v_exp_f32 v195, v195
    v_exp_f32 v196, v196
    v_exp_f32 v197, v197
    s_waitcnt lgkmcnt(6)
    v_mfma_f32_32x32x4_2b_bf16 v[224:255], v[156:157], v[12:13], 0
    v_exp_f32 v198, v198
    v_exp_f32 v199, v199
    v_exp_f32 v200, v200
    v_exp_f32 v201, v201
    v_exp_f32 v202, v202
    v_exp_f32 v203, v203
    v_exp_f32 v204, v204
    v_exp_f32 v205, v205
    v_smfmac_f32_32x32x32_bf16 v[176:191], v[132:135], v[192:199], v14
    v_exp_f32 v206, v206
    v_exp_f32 v207, v207
    v_exp_f32 v208, v208
    v_exp_f32 v209, v209
    v_smfmac_f32_32x32x32_bf16 v[176:191], v[136:139], v[200:207], v14
    s_mov_b64 exec, s[46:47]
    ds_read_b128 v[132:135], v17 offset:9728
    ds_read_b128 v[136:139], v17 offset:10304
    s_mov_b64 exec, -1
    v_exp_f32 v210, v210
    v_exp_f32 v211, v211
    v_exp_f32 v212, v212
    v_exp_f32 v213, v213
    s_waitcnt lgkmcnt(6)
    v_mfma_f32_32x32x16_bf16 v[224:239], v[148:151], v[8:11], v[224:239]
    ds_read_b32 v156, v16 offset:19456
    ds_read_b64 v[148:149], v15 offset:19456
    ds_read_b64 v[150:151], v15 offset:19968
    v_exp_f32 v214, v214
    v_exp_f32 v215, v215
    v_exp_f32 v216, v216
    v_exp_f32 v217, v217
    s_waitcnt lgkmcnt(5)
    v_smfmac_f32_32x32x32_bf16 v[176:191], v[140:143], v[208:215], v14
    v_exp_f32 v218, v218
    v_exp_f32 v219, v219
    v_exp_f32 v220, v220
    v_exp_f32 v221, v221
    v_mfma_f32_32x32x16_bf16 v[240:255], v[152:155], v[8:11], v[240:255]
    ds_read_b64 v[152:153], v15 offset:19712
    ds_read_b64 v[154:155], v15 offset:20224
    v_exp_f32 v222, v222
    v_exp_f32 v223, v223
    v_exp_f32 v224, v224
    v_exp_f32 v225, v225
    v_smfmac_f32_32x32x32_bf16 v[176:191], v[144:147], v[216:223], v14
    s_mov_b64 exec, s[46:47]
    ds_read_b128 v[140:143], v17 offset:10880
    ds_read_b128 v[144:147], v17 offset:11456
    s_mov_b64 exec, -1
    v_exp_f32 v226, v226
    v_exp_f32 v227, v227
    v_exp_f32 v228, v228
    v_exp_f32 v229, v229
    s_waitcnt lgkmcnt(6)
    v_mfma_f32_32x32x4_2b_bf16 v[192:223], v[156:157], v[12:13], 0
    v_exp_f32 v230, v230
    v_exp_f32 v231, v231
    v_exp_f32 v232, v232
    v_exp_f32 v233, v233
    v_exp_f32 v234, v234
    v_exp_f32 v235, v235
    v_exp_f32 v236, v236
    v_exp_f32 v237, v237
    v_smfmac_f32_32x32x32_bf16 v[176:191], v[132:135], v[224:231], v14
    v_exp_f32 v238, v238
    v_exp_f32 v239, v239
    v_exp_f32 v240, v240
    v_exp_f32 v241, v241
    v_smfmac_f32_32x32x32_bf16 v[176:191], v[136:139], v[232:239], v14
    s_mov_b64 exec, s[46:47]
    ds_read_b128 v[132:135], v17 offset:19456
    ds_read_b128 v[136:139], v17 offset:20032
    s_mov_b64 exec, -1
    v_exp_f32 v242, v242
    v_exp_f32 v243, v243
    v_exp_f32 v244, v244
    v_exp_f32 v245, v245
    s_waitcnt lgkmcnt(6)
L_pad2:
    s_cbranch_execz L_warm_ret
    v_mfma_f32_32x32x16_bf16 v[192:207], v[148:151], v[8:11], v[192:207]
    ds_read_b32 v156, v16 offset:29184
    ds_read_b64 v[148:149], v15 offset:29184
    ds_read_b64 v[150:151], v15 offset:29696
    v_exp_f32 v246, v246
    v_exp_f32 v247, v247
    v_exp_f32 v248, v248
    v_exp_f32 v249, v249
    s_waitcnt lgkmcnt(5)
    v_smfmac_f32_32x32x32_bf16 v[176:191], v[140:143], v[240:247], v14
    v_exp_f32 v250, v250
    v_exp_f32 v251, v251
    v_exp_f32 v252, v252
    v_exp_f32 v253, v253
    v_mfma_f32_32x32x16_bf16 v[208:223], v[152:155], v[8:11], v[208:223]
    ds_read_b64 v[152:153], v15 offset:29440
    ds_read_b64 v[154:155], v15 offset:29952
    v_exp_f32 v254, v254
    v_exp_f32 v255, v255
    v_exp_f32 v192, v192
    v_exp_f32 v193, v193
    v_smfmac_f32_32x32x32_bf16 v[176:191], v[144:147], v[248:255], v14
    s_mov_b64 exec, s[46:47]
    ds_read_b128 v[140:143], v17 offset:20608
    ds_read_b128 v[144:147], v17 offset:21184
    s_mov_b64 exec, -1
    v_exp_f32 v194, v194
    v_exp_f32 v195, v195
    v_exp_f32 v196, v196
    v_exp_f32 v197, v197
    s_waitcnt lgkmcnt(6)
    v_mfma_f32_32x32x4_2b_bf16 v[224:255], v[156:157], v[12:13], 0
    v_exp_f32 v198, v198
    v_exp_f32 v199, v199
    v_exp_f32 v200, v200
    v_exp_f32 v201, v201
    v_exp_f32 v202, v202
    v_exp_f32 v203, v203
    v_exp_f32 v204, v204
    v_exp_f32 v205, v205
    v_smfmac_f32_32x32x32_bf16 v[176:191], v[132:135], v[192:199], v14
    v_exp_f32 v206, v206
    v_exp_f32 v207, v207
    v_exp_f32 v208, v208
    v_exp_f32 v209, v209
    v_smfmac_f32_32x32x32_bf16 v[176:191], v[136:139], v[200:207], v14
    s_mov_b64 exec, s[46:47]
    ds_read_b128 v[132:135], v17 offset:29184
    ds_read_b128 v[136:139], v17 offset:29760
    s_mov_b64 exec, -1
    v_exp_f32 v210, v210
    v_exp_f32 v211, v211
    v_exp_f32 v212, v212
    v_exp_f32 v213, v213
    s_waitcnt lgkmcnt(6)
    v_mfma_f32_32x32x16_bf16 v[224:239], v[148:151], v[8:11], v[224:239]
    ds_read_b32 v156, v16 offset:38912
    ds_read_b64 v[148:149], v15 offset:38912
    ds_read_b64 v[150:151], v15 offset:39424
    v_exp_f32 v214, v214
    v_exp_f32 v215, v215
    v_exp_f32 v216, v216
    v_exp_f32 v217, v217
    s_waitcnt lgkmcnt(5)
    v_smfmac_f32_32x32x32_bf16 v[176:191], v[140:143], v[208:215], v14
    v_exp_f32 v218, v218
    v_exp_f32 v219, v219
    v_exp_f32 v220, v220
    v_exp_f32 v221, v221
    v_mfma_f32_32x32x16_bf16 v[240:255], v[152:155], v[8:11], v[240:255]
    ds_read_b64 v[152:153], v15 offset:39168
    ds_read_b64 v[154:155], v15 offset:39680
    v_exp_f32 v222, v222
    v_exp_f32 v223, v223
    v_exp_f32 v224, v224
    v_exp_f32 v225, v225
    v_smfmac_f32_32x32x32_bf16 v[176:191], v[144:147], v[216:223], v14
    s_mov_b64 exec, s[46:47]
    ds_read_b128 v[140:143], v17 offset:30336
    ds_read_b128 v[144:147], v17 offset:30912
    s_mov_b64 exec, -1
    v_exp_f32 v226, v226
    v_exp_f32 v227, v227
    v_exp_f32 v228, v228
    v_exp_f32 v229, v229
    s_waitcnt lgkmcnt(6)
    v_mfma_f32_32x32x4_2b_bf16 v[192:223], v[156:157], v[12:13], 0
    v_exp_f32 v230, v230
    v_exp_f32 v231, v231
    v_exp_f32 v232, v232
    v_exp_f32 v233, v233
    v_exp_f32 v234, v234
    v_exp_f32 v235, v235
    v_exp_f32 v236, v236
    v_exp_f32 v237, v237
    v_smfmac_f32_32x32x32_bf16 v[176:191], v[132:135], v[224:231], v14
    v_exp_f32 v238, v238
    v_exp_f32 v239, v239
    v_exp_f32 v240, v240
    v_exp_f32 v241, v241
    v_smfmac_f32_32x32x32_bf16 v[176:191], v[136:139], v[232:239], v14
    s_mov_b64 exec, s[46:47]
    ds_read_b128 v[132:135], v17 offset:38912
    ds_read_b128 v[136:139], v17 offset:39488
    s_mov_b64 exec, -1
    v_exp_f32 v242, v242
    v_exp_f32 v243, v243
    v_exp_f32 v244, v244
    v_exp_f32 v245, v245
    s_waitcnt lgkmcnt(6)
    v_mfma_f32_32x32x16_bf16 v[192:207], v[148:151], v[8:11], v[192:207]
    ds_read_b32 v156, v16 offset:48640
    ds_read_b64 v[148:149], v15 offset:48640
    ds_read_b64 v[150:151], v15 offset:49152
    v_exp_f32 v246, v246
    v_exp_f32 v247, v247
    v_exp_f32 v248, v248
    v_exp_f32 v249, v249
    s_waitcnt lgkmcnt(5)
    v_smfmac_f32_32x32x32_bf16 v[176:191], v[140:143], v[240:247], v14
    v_exp_f32 v250, v250
    v_exp_f32 v251, v251
    v_exp_f32 v252, v252
    v_exp_f32 v253, v253
    v_mfma_f32_32x32x16_bf16 v[208:223], v[152:155], v[8:11], v[208:223]
    ds_read_b64 v[152:153], v15 offset:48896
    ds_read_b64 v[154:155], v15 offset:49408
    v_exp_f32 v254, v254
    v_exp_f32 v255, v255
    v_exp_f32 v192, v192
    v_exp_f32 v193, v193
    v_smfmac_f32_32x32x32_bf16 v[176:191], v[144:147], v[248:255], v14
    s_mov_b64 exec, s[46:47]
    ds_read_b128 v[140:143], v17 offset:40064
    ds_read_b128 v[144:147], v17 offset:40640
    s_mov_b64 exec, -1
    v_exp_f32 v194, v194
    v_exp_f32 v195, v195
    v_exp_f32 v196, v196
    v_exp_f32 v197, v197
    s_waitcnt lgkmcnt(6)
    v_mfma_f32_32x32x4_2b_bf16 v[224:255], v[156:157], v[12:13], 0
    v_exp_f32 v198, v198
    v_exp_f32 v199, v199
    v_exp_f32 v200, v200
    v_exp_f32 v201, v201
    v_exp_f32 v202, v202
    v_exp_f32 v203, v203
    v_exp_f32 v204, v204
    v_exp_f32 v205, v205
    v_smfmac_f32_32x32x32_bf16 v[176:191], v[132:135], v[192:199], v14
    v_exp_f32 v206, v206
    v_exp_f32 v207, v207
    v_exp_f32 v208, v208
    v_exp_f32 v209, v209
    v_smfmac_f32_32x32x32_bf16 v[176:191], v[136:139], v[200:207], v14
    s_mov_b64 exec, s[46:47]
    ds_read_b128 v[132:135], v17 offset:48640
    ds_read_b128 v[136:139], v17 offset:49216
    s_mov_b64 exec, -1
    v_exp_f32 v210, v210
    v_exp_f32 v211, v211
    v_exp_f32 v212, v212
    v_exp_f32 v213, v213
    s_waitcnt lgkmcnt(6)
    v_mfma_f32_32x32x16_bf16 v[224:239], v[148:151], v[8:11], v[224:239]
    v_exp_f32 v214, v214
    v_exp_f32 v215, v215
    v_exp_f32 v216, v216
    v_exp_f32 v217, v217
    s_waitcnt lgkmcnt(2)
    v_smfmac_f32_32x32x32_bf16 v[176:191], v[140:143], v[208:215], v14
    s_setprio 1
    buffer_load_dword v39, v37, s[20:23], 0 offen offset:0 sc1
    v_exp_f32 v218, v218
    v_exp_f32 v219, v219
    v_exp_f32 v220, v220
    v_exp_f32 v221, v221
    v_mfma_f32_32x32x16_bf16 v[240:255], v[152:155], v[8:11], v[240:255]
    v_exp_f32 v222, v222
    v_exp_f32 v223, v223
    v_exp_f32 v224, v224
    v_exp_f32 v225, v225
    v_smfmac_f32_32x32x32_bf16 v[176:191], v[144:147], v[216:223], v14
    s_mov_b64 exec, s[46:47]
    ds_read_b128 v[140:143], v17 offset:49792
    ds_read_b128 v[144:147], v17 offset:50368
    s_mov_b64 exec, -1
    v_exp_f32 v226, v226
    v_exp_f32 v227, v227
    v_exp_f32 v228, v228
    v_exp_f32 v229, v229
    s_waitcnt vmcnt(0)
L_poll_18:
    v_cmp_ne_u32 vcc, s31, v39
    s_cbranch_vccnz L_poll_18_r
L_poll_18_k:
    buffer_load_dword v2, v29, s[20:23], s14 offen offset:0 sc1
    buffer_load_dword v3, v29, s[20:23], s14 offen offset:128 sc1
    buffer_load_dwordx4 v[160:163], v28, s[20:23], s12 offen offset:0 sc1
    buffer_load_dwordx4 v[164:167], v28, s[20:23], s12 offen offset:2048 sc1
    buffer_load_dwordx4 v[168:171], v28, s[20:23], s13 offen offset:0 sc1
    buffer_load_dwordx4 v[172:175], v28, s[20:23], s13 offen offset:2048 sc1
    buffer_load_dword v208, v19, s[20:23], s14 offen offset:0 sc1
    buffer_load_dword v209, v19, s[20:23], s14 offen offset:128 sc1
    buffer_load_dwordx4 v[192:195], v18, s[20:23], s12 offen offset:0 sc1
    buffer_load_dwordx4 v[196:199], v18, s[20:23], s12 offen offset:2048 sc1
    buffer_load_dwordx4 v[200:203], v18, s[20:23], s13 offen offset:0 sc1
    buffer_load_dwordx4 v[204:207], v18, s[20:23], s13 offen offset:2048 sc1
    v_exp_f32 v230, v230
    v_exp_f32 v231, v231
    v_exp_f32 v232, v232
    v_exp_f32 v233, v233
    v_exp_f32 v234, v234
    v_exp_f32 v235, v235
    v_exp_f32 v236, v236
    v_exp_f32 v237, v237
    s_waitcnt lgkmcnt(2)
    v_smfmac_f32_32x32x32_bf16 v[176:191], v[132:135], v[224:231], v14
    s_setprio 0
    v_exp_f32 v238, v238
    v_exp_f32 v239, v239
    v_exp_f32 v240, v240
    v_exp_f32 v241, v241
    v_smfmac_f32_32x32x32_bf16 v[176:191], v[136:139], v[232:239], v14
    ds_read_b32 v4, v159 offset:256
    ds_read_b32 v5, v159 offset:288
    buffer_load_dword v39, v37, s[20:23], 0 offen offset:4 sc1
    v_exp_f32 v242, v242
    v_exp_f32 v243, v243
    v_exp_f32 v244, v244
    v_exp_f32 v245, v245
    v_exp_f32 v246, v246
    v_exp_f32 v247, v247
    v_exp_f32 v248, v248
    v_exp_f32 v249, v249
    s_waitcnt lgkmcnt(2)
    v_smfmac_f32_32x32x32_bf16 v[176:191], v[140:143], v[240:247], v14
    v_exp_f32 v250, v250
    v_exp_f32 v251, v251
    v_exp_f32 v252, v252
    v_exp_f32 v253, v253
    v_exp_f32 v254, v254
    v_exp_f32 v255, v255
    s_nop 1
    v_smfmac_f32_32x32x32_bf16 v[176:191], v[144:147], v[248:255], v14
    s_waitcnt lgkmcnt(0)
L_word_19:
    v_cmp_ne_u32 vcc, s31, v4
    s_cbranch_vccnz L_word_19_r
    v_cmp_ne_u32 vcc, s31, v5
    s_cbranch_vccnz L_word_19_r
L_word_19_k:
    s_nop 7
    v_mov_b32 v187, s31
    ds_write_b128 v26, v[176:179] offset:0
    ds_write_b128 v26, v[180:183] offset:1024
    ds_write_b128 v27, v[184:187] offset:9728
    s_waitcnt vmcnt(0)
    s_mov_b32 s38, 0
    v_cmp_ne_u32 vcc, s31, v39
    s_and_b32 vcc_lo, vcc_lo, 15
    s_cbranch_scc1 L_xw
    s_mov_b32 s38, 1
    buffer_load_dwordx4 v[224:227], v28, s[20:23], s35 offen offset:0 sc1
    buffer_load_dwordx4 v[228:231], v28, s[20:23], s35 offen offset:2048 sc1
    buffer_load_dwordx4 v[240:243], v18, s[20:23], s35 offen offset:0 sc1
    buffer_load_dwordx4 v[244:247], v18, s[20:23], s35 offen offset:2048 sc1
L_xw:
    ds_read_b32 v24, v158 offset:480
    s_waitcnt lgkmcnt(0)
    v_cmp_ne_u32 vcc, s31, v24
    s_cbranch_vccnz L_xw2
L_xw3:
    buffer_load_dword v39, v37, s[20:23], 0 offen offset:4 sc1
    v_mfma_f32_16x16x16_bf16 v[148:151], v[130:131], v[2:3], 0
    v_mfma_f32_16x16x16_bf16 v[132:135], v[58:59], v[2:3], 0
    v_mfma_f32_16x16x16_bf16 v[136:139], v[76:77], v[2:3], 0
    v_mfma_f32_16x16x16_bf16 v[140:143], v[94:95], v[2:3], 0
    v_mfma_f32_16x16x16_bf16 v[144:147], v[112:113], v[2:3], 0
    s_nop 1
    v_mfma_f32_16x16x32_bf16 v[148:151], v[114:117], v[160:163], v[148:151]
    v_mfma_f32_16x16x32_bf16 v[148:151], v[118:121], v[164:167], v[148:151]
    v_mfma_f32_16x16x32_bf16 v[148:151], v[122:125], v[168:171], v[148:151]
    v_mfma_f32_16x16x32_bf16 v[148:151], v[126:129], v[172:175], v[148:151]
    v_mfma_f32_16x16x32_bf16 v[132:135], v[42:45], v[160:163], v[132:135]
    v_mfma_f32_16x16x32_bf16 v[132:135], v[46:49], v[164:167], v[132:135]
    v_mfma_f32_16x16x32_bf16 v[132:135], v[50:53], v[168:171], v[132:135]
    v_mfma_f32_16x16x32_bf16 v[132:135], v[54:57], v[172:175], v[132:135]
    v_mfma_f32_16x16x32_bf16 v[136:139], v[60:63], v[160:163], v[136:139]
    v_mfma_f32_16x16x32_bf16 v[136:139], v[64:67], v[164:167], v[136:139]
    v_mfma_f32_16x16x32_bf16 v[136:139], v[68:71], v[168:171], v[136:139]
    v_mfma_f32_16x16x32_bf16 v[136:139], v[72:75], v[172:175], v[136:139]
    ds_write_b128 v31, v[148:151] offset:39936
    v_mfma_f32_16x16x32_bf16 v[140:143], v[78:81], v[160:163], v[140:143]
    v_mfma_f32_16x16x32_bf16 v[140:143], v[82:85], v[164:167], v[140:143]
    v_mfma_f32_16x16x32_bf16 v[140:143], v[86:89], v[168:171], v[140:143]
    ds_write_b128 v30, v[132:135] offset:39936
    v_mfma_f32_16x16x32_bf16 v[140:143], v[90:93], v[172:175], v[140:143]
    v_mfma_f32_16x16x32_bf16 v[144:147], v[96:99], v[160:163], v[144:147]
    v_mfma_f32_16x16x32_bf16 v[144:147], v[100:103], v[164:167], v[144:147]
    v_mfma_f32_16x16x32_bf16 v[144:147], v[104:107], v[168:171], v[144:147]
    ds_write_b128 v30, v[136:139] offset:40000
    v_mfma_f32_16x16x32_bf16 v[144:147], v[108:111], v[172:175], v[144:147]
    v_mfma_f32_16x16x16_bf16 v[176:179], v[58:59], v[208:209], 0
    v_mfma_f32_16x16x16_bf16 v[180:183], v[76:77], v[208:209], 0
    v_mfma_f32_16x16x16_bf16 v[184:187], v[94:95], v[208:209], 0
    ds_write_b128 v30, v[140:143] offset:40064
    v_mfma_f32_16x16x16_bf16 v[188:191], v[112:113], v[208:209], 0
    s_nop 1
    v_mfma_f32_16x16x32_bf16 v[176:179], v[42:45], v[192:195], v[176:179]
    ds_write_b128 v30, v[144:147] offset:40128
    v_mfma_f32_16x16x32_bf16 v[176:179], v[46:49], v[196:199], v[176:179]
    v_mfma_f32_16x16x32_bf16 v[176:179], v[50:53], v[200:203], v[176:179]
    v_mfma_f32_16x16x32_bf16 v[176:179], v[54:57], v[204:207], v[176:179]
    v_mfma_f32_16x16x32_bf16 v[180:183], v[60:63], v[192:195], v[180:183]
    v_mfma_f32_16x16x32_bf16 v[180:183], v[64:67], v[196:199], v[180:183]
    v_mfma_f32_16x16x32_bf16 v[180:183], v[68:71], v[200:203], v[180:183]
    v_mfma_f32_16x16x32_bf16 v[180:183], v[72:75], v[204:207], v[180:183]
    v_mfma_f32_16x16x32_bf16 v[184:187], v[78:81], v[192:195], v[184:187]
    v_mfma_f32_16x16x32_bf16 v[184:187], v[82:85], v[196:199], v[184:187]
    v_mfma_f32_16x16x32_bf16 v[184:187], v[86:89], v[200:203], v[184:187]
    v_mfma_f32_16x16x32_bf16 v[184:187], v[90:93], v[204:207], v[184:187]
    ds_write_b128 v30, v[176:179] offset:57344
    v_mfma_f32_16x16x32_bf16 v[188:191], v[96:99], v[192:195], v[188:191]
    v_mfma_f32_16x16x32_bf16 v[188:191], v[100:103], v[196:199], v[188:191]
    v_mfma_f32_16x16x32_bf16 v[188:191], v[104:107], v[200:203], v[188:191]
    ds_write_b128 v30, v[180:183] offset:57408
    v_mfma_f32_16x16x32_bf16 v[188:191], v[108:111], v[204:207], v[188:191]
    s_nop 2
    ds_write_b128 v30, v[184:187] offset:57472
    s_nop 3
    ds_write_b128 v30, v[188:191] offset:57536
    s_mov_b64 exec, 1
    ds_write_b32 v158, v0 offset:384
    s_mov_b64 exec, -1
    s_cmp_eq_u32 s38, 0
    s_cbranch_scc1 L_g1
    s_waitcnt vmcnt(0)
L_g1k:
    s_mov_b32 s39, 1
    v_cmp_ne_u32 vcc, s31, v39
    s_cbranch_vccnz L_g2
    buffer_load_dword v152, v29, s[20:23], s37 offen offset:0 sc1
    buffer_load_dword v153, v29, s[20:23], s37 offen offset:128 sc1
    buffer_load_dwordx4 v[232:235], v28, s[20:23], s36 offen offset:0 sc1
    buffer_load_dwordx4 v[236:239], v28, s[20:23], s36 offen offset:2048 sc1
    buffer_load_dword v154, v19, s[20:23], s37 offen offset:0 sc1
    buffer_load_dword v155, v19, s[20:23], s37 offen offset:128 sc1
    buffer_load_dwordx4 v[248:251], v18, s[20:23], s36 offen offset:0 sc1
    buffer_load_dwordx4 v[252:255], v18, s[20:23], s36 offen offset:2048 sc1
    s_waitcnt vmcnt(8)
L_g2k:
    v_max_u32 v24, v224, v225
    v_max3_u32 v24, v24, v226, v227
    v_max3_u32 v24, v24, v228, v229
    v_max3_u32 v24, v24, v230, v231
    v_max3_u32 v24, v24, v240, v241
    v_max3_u32 v24, v24, v242, v243
    v_max3_u32 v24, v24, v244, v245
    v_max3_u32 v24, v24, v246, v247
    v_cmp_eq_u32 vcc, -1, v24
    s_cbranch_vccnz L_ochk_20_r
L_ochk_20_k:
    v_mfma_f32_16x16x32_bf16 v[148:151], v[114:117], v[224:227], 0
    v_mfma_f32_16x16x32_bf16 v[148:151], v[118:121], v[228:231], v[148:151]
    v_mfma_f32_16x16x32_bf16 v[132:135], v[42:45], v[224:227], 0
    v_mfma_f32_16x16x32_bf16 v[132:135], v[46:49], v[228:231], v[132:135]
    v_mfma_f32_16x16x32_bf16 v[136:139], v[60:63], v[224:227], 0
    v_mfma_f32_16x16x32_bf16 v[136:139], v[64:67], v[228:231], v[136:139]
    v_mfma_f32_16x16x32_bf16 v[140:143], v[78:81], v[224:227], 0
    v_mfma_f32_16x16x32_bf16 v[140:143], v[82:85], v[228:231], v[140:143]
    v_mfma_f32_16x16x32_bf16 v[144:147], v[96:99], v[224:227], 0
    v_mfma_f32_16x16x32_bf16 v[144:147], v[100:103], v[228:231], v[144:147]
    v_mfma_f32_16x16x32_bf16 v[176:179], v[42:45], v[240:243], 0
    v_mfma_f32_16x16x32_bf16 v[176:179], v[46:49], v[244:247], v[176:179]
    v_mfma_f32_16x16x32_bf16 v[180:183], v[60:63], v[240:243], 0
    v_mfma_f32_16x16x32_bf16 v[180:183], v[64:67], v[244:247], v[180:183]
    v_mfma_f32_16x16x32_bf16 v[184:187], v[78:81], v[240:243], 0
    v_mfma_f32_16x16x32_bf16 v[184:187], v[82:85], v[244:247], v[184:187]
    v_mfma_f32_16x16x32_bf16 v[188:191], v[96:99], v[240:243], 0
    v_mfma_f32_16x16x32_bf16 v[188:191], v[100:103], v[244:247], v[188:191]
    s_cmp_eq_u32 s39, 0
    s_cbranch_scc1 L_g3
L_g3k:
    s_waitcnt vmcnt(4)
    v_max_u32 v24, v152, v153
    v_max3_u32 v24, v24, v232, v233
    v_max3_u32 v24, v24, v234, v235
    v_max3_u32 v24, v24, v236, v237
    v_max3_u32 v24, v24, v238, v239
    v_cmp_eq_u32 vcc, -1, v24
    s_cbranch_vccnz L_ochk_21_r
L_ochk_21_k:
    v_mfma_f32_16x16x16_bf16 v[148:151], v[130:131], v[152:153], v[148:151]
    v_mfma_f32_16x16x16_bf16 v[132:135], v[58:59], v[152:153], v[132:135]
    v_mfma_f32_16x16x16_bf16 v[136:139], v[76:77], v[152:153], v[136:139]
    v_mfma_f32_16x16x16_bf16 v[140:143], v[94:95], v[152:153], v[140:143]
    v_mfma_f32_16x16x16_bf16 v[144:147], v[112:113], v[152:153], v[144:147]
    s_waitcnt vmcnt(0)
    s_nop 0
    v_mfma_f32_16x16x32_bf16 v[148:151], v[122:125], v[232:235], v[148:151]
    v_max_u32 v24, v154, v155
    v_mfma_f32_16x16x32_bf16 v[148:151], v[126:129], v[236:239], v[148:151]
    v_max3_u32 v24, v24, v248, v249
    v_mfma_f32_16x16x32_bf16 v[132:135], v[50:53], v[232:235], v[132:135]
    v_max3_u32 v24, v24, v250, v251
    v_mfma_f32_16x16x32_bf16 v[132:135], v[54:57], v[236:239], v[132:135]
    v_max3_u32 v24, v24, v252, v253
    v_mfma_f32_16x16x32_bf16 v[136:139], v[68:71], v[232:235], v[136:139]
    v_max3_u32 v24, v24, v254, v255
    v_mfma_f32_16x16x32_bf16 v[136:139], v[72:75], v[236:239], v[136:139]
    v_cmp_eq_u32 vcc, -1, v24
    ds_write_b128 v31, v[148:151] offset:0
    v_mfma_f32_16x16x32_bf16 v[140:143], v[86:89], v[232:235], v[140:143]
    v_mfma_f32_16x16x32_bf16 v[140:143], v[90:93], v[236:239], v[140:143]
    v_mfma_f32_16x16x32_bf16 v[144:147], v[104:107], v[232:235], v[144:147]
    ds_write_b128 v30, v[132:135] offset:0
    v_mfma_f32_16x16x32_bf16 v[144:147], v[108:111], v[236:239], v[144:147]
    s_cbranch_vccnz L_ochk_22_r
L_ochk_22_k:
    v_mfma_f32_16x16x16_bf16 v[176:179], v[58:59], v[154:155], v[176:179]
    v_mfma_f32_16x16x16_bf16 v[180:183], v[76:77], v[154:155], v[180:183]
    v_mfma_f32_16x16x16_bf16 v[184:187], v[94:95], v[154:155], v[184:187]
    ds_write_b128 v30, v[136:139] offset:64
    v_mfma_f32_16x16x16_bf16 v[188:191], v[112:113], v[154:155], v[188:191]
    ds_write_b128 v30, v[140:143] offset:128
    s_nop 0
    v_mfma_f32_16x16x32_bf16 v[176:179], v[50:53], v[248:251], v[176:179]
    ds_write_b128 v30, v[144:147] offset:192
    v_mfma_f32_16x16x32_bf16 v[176:179], v[54:57], v[252:255], v[176:179]
    v_mfma_f32_16x16x32_bf16 v[180:183], v[68:71], v[248:251], v[180:183]
    v_mfma_f32_16x16x32_bf16 v[180:183], v[72:75], v[252:255], v[180:183]
    v_mfma_f32_16x16x32_bf16 v[184:187], v[86:89], v[248:251], v[184:187]
    v_mfma_f32_16x16x32_bf16 v[184:187], v[90:93], v[252:255], v[184:187]
    v_mfma_f32_16x16x32_bf16 v[188:191], v[104:107], v[248:251], v[188:191]
    v_mfma_f32_16x16x32_bf16 v[188:191], v[108:111], v[252:255], v[188:191]
    s_nop 1
    ds_write_b128 v30, v[176:179] offset:17408
    s_nop 0
    ds_write_b128 v30, v[180:183] offset:17472
    s_nop 0
    ds_write_b128 v30, v[184:187] offset:17536
    s_nop 0
    ds_write_b128 v30, v[188:191] offset:17600
    s_waitcnt lgkmcnt(0)
    s_barrier
    ds_read_b128 v[44:47], v32 offset:0
    ds_read_b128 v[48:51], v32 offset:4352
    ds_read_b128 v[52:55], v32 offset:8704
    ds_read_b128 v[56:59], v32 offset:13056
    s_waitcnt lgkmcnt(2)
    v_pk_add_f32 v[44:45], v[44:45], v[48:49]
    v_pk_add_f32 v[46:47], v[46:47], v[50:51]
    s_waitcnt lgkmcnt(1)
    v_pk_add_f32 v[44:45], v[44:45], v[52:53]
    v_pk_add_f32 v[46:47], v[46:47], v[54:55]
    s_waitcnt lgkmcnt(0)
    v_pk_add_f32 v[44:45], v[44:45], v[56:57]
    v_pk_add_f32 v[46:47], v[46:47], v[58:59]
    v_cvt_pk_bf16_f32 v44, v44, v45
    v_cvt_pk_bf16_f32 v45, v46, v47
    buffer_store_dwordx2 v[44:45], v34, s[16:19], s75 offen
L_end:
L_exit:
    s_endpgm
L_word_11_r:
L_pad3:
    s_cbranch_execz L_warm_ret
    s_add_u32 s68, s68, 1
    s_cmp_gt_u32 s68, 0x80000
    s_cbranch_scc1 L_word_11_k
    s_sleep 1
    ds_read_b32 v24, v159 offset:0
    s_waitcnt lgkmcnt(0)
    s_branch L_word_11
L_word_12_r:
    s_add_u32 s68, s68, 1
    s_cmp_gt_u32 s68, 0x80000
    s_cbranch_scc1 L_word_12_k
    s_sleep 1
    ds_read_b32 v24, v159 offset:64
    s_waitcnt lgkmcnt(0)
    s_branch L_word_12
L_word_13_r:
    s_add_u32 s68, s68, 1
    s_cmp_gt_u32 s68, 0x80000
    s_cbranch_scc1 L_word_13_k
    s_sleep 1
    ds_read_b32 v24, v159 offset:4864
    ds_read_b32 v25, v159 offset:4896
    s_waitcnt lgkmcnt(0)
    s_branch L_word_13
L_poll_14_r:
    s_add_u32 s68, s68, 1
    s_cmp_gt_u32 s68, 0x80000
    s_cbranch_scc1 L_poll_14_k
    s_sleep 2
    buffer_load_dword v39, v38, s[20:23], 0 offen offset:4 sc1
    s_waitcnt vmcnt(0)
    s_branch L_poll_14
L_word_15_r:
    s_add_u32 s68, s68, 1
    s_cmp_gt_u32 s68, 0x80000
    s_cbranch_scc1 L_word_15_k
    s_sleep 1
    ds_read_b32 v24, v159 offset:128
    s_waitcnt lgkmcnt(0)
    s_branch L_word_15
L_poll_16_r:
    s_add_u32 s68, s68, 1
    s_cmp_gt_u32 s68, 0x80000
    s_cbranch_scc1 L_poll_16_k
    s_sleep 2
    buffer_load_dword v39, v36, s[20:23], 0 offen offset:0 sc1
    s_waitcnt vmcnt(0)
    s_branch L_poll_16
L_word_17_r:
    s_add_u32 s68, s68, 1
    s_cmp_gt_u32 s68, 0x80000
    s_cbranch_scc1 L_word_17_k
    s_sleep 1
    ds_read_b32 v24, v159 offset:192
    s_waitcnt lgkmcnt(0)
    s_branch L_word_17
L_poll_18_r:
    s_add_u32 s68, s68, 1
    s_cmp_gt_u32 s68, 0x80000
    s_cbranch_scc1 L_poll_18_k
    s_sleep 2
    buffer_load_dword v39, v37, s[20:23], 0 offen offset:0 sc1
    s_waitcnt vmcnt(0)
    s_branch L_poll_18
L_word_19_r:
    s_add_u32 s68, s68, 1
    s_cmp_gt_u32 s68, 0x80000
    s_cbranch_scc1 L_word_19_k
    s_sleep 1
    ds_read_b32 v4, v159 offset:256
    ds_read_b32 v5, v159 offset:288
    s_waitcnt lgkmcnt(0)
    s_branch L_word_19
L_xw2:
    s_add_u32 s68, s68, 1
    s_cmp_gt_u32 s68, 0x80000
    s_cbranch_scc1 L_xw3
    s_branch L_xw
L_g1:
    s_waitcnt vmcnt(0)
L_poll_23:
    v_cmp_ne_u32 vcc, s31, v39
    s_and_b32 vcc_lo, vcc_lo, 15
    s_cbranch_scc1 L_poll_23_r
L_poll_23_k:
    buffer_load_dwordx4 v[224:227], v28, s[20:23], s35 offen offset:0 sc1
    buffer_load_dwordx4 v[228:231], v28, s[20:23], s35 offen offset:2048 sc1
    buffer_load_dwordx4 v[240:243], v18, s[20:23], s35 offen offset:0 sc1
    buffer_load_dwordx4 v[244:247], v18, s[20:23], s35 offen offset:2048 sc1
    s_branch L_g1k
L_g2:
    s_mov_b32 s39, 0
    buffer_load_dword v39, v37, s[20:23], 0 offen offset:4 sc1
    s_waitcnt vmcnt(1)
    s_branch L_g2k
L_ochk_20_r:
    s_add_u32 s68, s68, 1
    s_cmp_gt_u32 s68, 0x80000
    s_cbranch_scc1 L_ochk_20_k
    s_sleep 1
    buffer_load_dwordx4 v[224:227], v28, s[20:23], s35 offen offset:0 sc1
    buffer_load_dwordx4 v[228:231], v28, s[20:23], s35 offen offset:2048 sc1
    buffer_load_dwordx4 v[240:243], v18, s[20:23], s35 offen offset:0 sc1
    buffer_load_dwordx4 v[244:247], v18, s[20:23], s35 offen offset:2048 sc1
    s_waitcnt vmcnt(0)
    v_max_u32 v24, v224, v225
    v_max3_u32 v24, v24, v226, v227
    v_max3_u32 v24, v24, v228, v229
    v_max3_u32 v24, v24, v230, v231
    v_max3_u32 v24, v24, v240, v241
    v_max3_u32 v24, v24, v242, v243
    v_max3_u32 v24, v24, v244, v245
    v_max3_u32 v24, v24, v246, v247
    v_cmp_eq_u32 vcc, -1, v24
    s_cbranch_vccnz L_ochk_20_r
    s_branch L_ochk_20_k
L_g3:
    s_waitcnt vmcnt(0)
L_poll_24:
    v_cmp_ne_u32 vcc, s31, v39
    s_cbranch_vccnz L_poll_24_r
L_poll_24_k:
    buffer_load_dword v152, v29, s[20:23], s37 offen offset:0 sc1
    buffer_load_dword v153, v29, s[20:23], s37 offen offset:128 sc1
    buffer_load_dwordx4 v[232:235], v28, s[20:23], s36 offen offset:0 sc1
    buffer_load_dwordx4 v[236:239], v28, s[20:23], s36 offen offset:2048 sc1
    buffer_load_dword v154, v19, s[20:23], s37 offen offset:0 sc1
    buffer_load_dword v155, v19, s[20:23], s37 offen offset:128 sc1
    buffer_load_dwordx4 v[248:251], v18, s[20:23], s36 offen offset:0 sc1
    buffer_load_dwordx4 v[252:255], v18, s[20:23], s36 offen offset:2048 sc1
    s_branch L_g3k
L_ochk_21_r:
    s_add_u32 s68, s68, 1
    s_cmp_gt_u32 s68, 0x80000
    s_cbranch_scc1 L_ochk_21_k
    s_sleep 1
    buffer_load_dword v152, v29, s[20:23], s37 offen offset:0 sc1
    buffer_load_dword v153, v29, s[20:23], s37 offen offset:128 sc1
    buffer_load_dwordx4 v[232:235], v28, s[20:23], s36 offen offset:0 sc1
    buffer_load_dwordx4 v[236:239], v28, s[20:23], s36 offen offset:2048 sc1
    buffer_load_dword v154, v19, s[20:23], s37 offen offset:0 sc1
    buffer_load_dword v155, v19, s[20:23], s37 offen offset:128 sc1
    buffer_load_dwordx4 v[248:251], v18, s[20:23], s36 offen offset:0 sc1
    buffer_load_dwordx4 v[252:255], v18, s[20:23], s36 offen offset:2048 sc1
    s_waitcnt vmcnt(0)
    v_max_u32 v24, v152, v153
    v_max3_u32 v24, v24, v232, v233
    v_max3_u32 v24, v24, v234, v235
    v_max3_u32 v24, v24, v236, v237
    v_max3_u32 v24, v24, v238, v239
    v_cmp_eq_u32 vcc, -1, v24
    s_cbranch_vccnz L_ochk_21_r
    s_branch L_ochk_21_k
L_ochk_22_r:
    s_add_u32 s68, s68, 1
    s_cmp_gt_u32 s68, 0x80000
    s_cbranch_scc1 L_ochk_22_k
    s_sleep 1
    buffer_load_dword v154, v19, s[20:23], s37 offen offset:0 sc1
    buffer_load_dword v155, v19, s[20:23], s37 offen offset:128 sc1
    buffer_load_dwordx4 v[248:251], v18, s[20:23], s36 offen offset:0 sc1
    buffer_load_dwordx4 v[252:255], v18, s[20:23], s36 offen offset:2048 sc1
    s_waitcnt vmcnt(0)
    v_max_u32 v24, v154, v155
    v_max3_u32 v24, v24, v248, v249
    v_max3_u32 v24, v24, v250, v251
    v_max3_u32 v24, v24, v252, v253
    v_max3_u32 v24, v24, v254, v255
    v_cmp_eq_u32 vcc, -1, v24
    s_cbranch_vccnz L_ochk_22_r
    s_branch L_ochk_22_k
L_poll_23_r:
    s_add_u32 s68, s68, 1
    s_cmp_gt_u32 s68, 0x80000
    s_cbranch_scc1 L_poll_23_k
    buffer_load_dword v39, v37, s[20:23], 0 offen offset:4 sc1
    s_waitcnt vmcnt(0)
    s_branch L_poll_23
L_poll_24_r:
    s_add_u32 s68, s68, 1
    s_cmp_gt_u32 s68, 0x80000
    s_cbranch_scc1 L_poll_24_k
    buffer_load_dword v39, v37, s[20:23], 0 offen offset:4 sc1
    s_waitcnt vmcnt(0)
    s_branch L_poll_24
L_end0:
.p2align 12
L_attn1:
L_pad4:
    s_cbranch_execz L_warm_ret
    s_lshr_b32 s60, s44, 1
    s_mul_i32 s60, s60, 2560
    s_and_b32 s61, s44, 1
    s_lshl_b32 s61, s61, 8
    s_add_u32 s60, s60, s61
    s_mul_i32 s61, s43, 4864
    s_sub_u32 s60, s60, s61
    s_add_u32 s60, s60, 155648
    v_add_u32 v24, s60, v15
    v_and_b32 v25, 32, v1
    v_lshlrev_b32 v25, 3, v25
    v_sub_u32 v25, v16, v25
    v_add_u32 v25, s60, v25
    s_setprio 3
    s_waitcnt vmcnt(5)
    s_cmp_eq_u32 s44, 3
    s_cbranch_scc1 L_b0_25
    s_waitcnt vmcnt(2)
    s_cmp_eq_u32 s44, 2
    s_cbranch_scc1 L_b0_25
    s_waitcnt vmcnt(0)
L_b0_25:
    s_barrier
    ds_read_b32 v6, v25
    ds_read_b64 v[2:3], v24 offset:0
    ds_read_b64 v[4:5], v24 offset:512
    ds_read_b32 v156, v16 offset:0
    ds_read_b64 v[148:149], v15 offset:0
    ds_read_b64 v[150:151], v15 offset:512
    ds_read_b64 v[152:153], v15 offset:256
    ds_read_b64 v[154:155], v15 offset:768
    s_mov_b64 exec, s[46:47]
    ds_read_b128 v[132:135], v17 offset:0
    ds_read_b128 v[136:139], v17 offset:576
    ds_read_b128 v[140:143], v17 offset:1152
    ds_read_b128 v[144:147], v17 offset:1728
    s_mov_b64 exec, -1
    s_waitcnt lgkmcnt(8)
    v_mfma_f32_32x32x4_2b_bf16 v[192:223], v[156:157], v[6:7], 0
    ds_read_b32 v156, v16 offset:9728
    s_add_u32 m0, s45, 38912
    s_add_u32 s50, s50, 1770496
    buffer_load_dwordx4 v18, s[20:23], s50 offen offset:0 sc1 lds
    buffer_load_dwordx4 v18, s[20:23], s50 offen offset:1024 sc1 lds
    buffer_load_dwordx4 v19, s[20:23], s50 offen offset:2048 sc1 lds
    s_nop 11
    s_waitcnt lgkmcnt(7)
    v_mfma_f32_32x32x16_bf16 v[192:207], v[148:151], v[2:5], v[192:207]
    ds_read_b64 v[148:149], v15 offset:9728
    ds_read_b64 v[150:151], v15 offset:10240
    s_waitcnt lgkmcnt(7)
    v_mfma_f32_32x32x16_bf16 v[208:223], v[152:155], v[2:5], v[208:223]
    ds_read_b64 v[152:153], v15 offset:9984
    ds_read_b64 v[154:155], v15 offset:10496
    s_nop 7
    v_exp_f32 v192, v192
    v_exp_f32 v193, v193
    v_exp_f32 v194, v194
    v_exp_f32 v195, v195
    v_exp_f32 v196, v196
    v_exp_f32 v197, v197
    s_waitcnt lgkmcnt(4)
    v_mfma_f32_32x32x4_2b_bf16 v[224:255], v[156:157], v[6:7], 0
    buffer_load_dwordx4 v20, s[20:23], s50 offen offset:3072 sc1 lds
    s_add_u32 m0, m0, 4096
    s_mov_b64 exec, s[48:49]
    buffer_load_dwordx4 v21, s[20:23], s50 offen sc1 lds
    s_mov_b64 exec, -1
    v_exp_f32 v198, v198
    v_exp_f32 v199, v199
    v_exp_f32 v200, v200
    v_exp_f32 v201, v201
    v_exp_f32 v202, v202
    v_exp_f32 v203, v203
    v_exp_f32 v204, v204
    v_exp_f32 v205, v205
    v_smfmac_f32_32x32x32_bf16 v[160:175], v[132:135], v[192:199], v14
    v_exp_f32 v206, v206
    v_exp_f32 v207, v207
    v_exp_f32 v208, v208
    v_exp_f32 v209, v209
    v_smfmac_f32_32x32x32_bf16 v[160:175], v[136:139], v[200:207], v14
    s_mov_b64 exec, s[46:47]
    ds_read_b128 v[132:135], v17 offset:9728
    ds_read_b128 v[136:139], v17 offset:10304
    s_mov_b64 exec, -1
    s_setprio 2
    v_exp_f32 v210, v210
    v_exp_f32 v211, v211
    v_exp_f32 v212, v212
    v_exp_f32 v213, v213
    s_waitcnt lgkmcnt(4)
    v_mfma_f32_32x32x16_bf16 v[224:239], v[148:151], v[2:5], v[224:239]
    ds_read_b32 v156, v16 offset:19456
    ds_read_b64 v[148:149], v15 offset:19456
    ds_read_b64 v[150:151], v15 offset:19968
    buffer_store_dwordx4 v[64:67], v46, s[20:23], s40 offen sc1
    buffer_store_dwordx4 v[72:75], v46, s[20:23], s39 offen sc1
    v_exp_f32 v214, v214
    v_exp_f32 v215, v215
    v_exp_f32 v216, v216
    v_exp_f32 v217, v217
    v_smfmac_f32_32x32x32_bf16 v[160:175], v[140:143], v[208:215], v14
    v_exp_f32 v218, v218
    v_exp_f32 v219, v219
    v_exp_f32 v220, v220
    v_exp_f32 v221, v221
    s_waitcnt lgkmcnt(5)
    v_mfma_f32_32x32x16_bf16 v[240:255], v[152:155], v[2:5], v[240:255]
    ds_read_b64 v[152:153], v15 offset:19712
    ds_read_b64 v[154:155], v15 offset:20224
    v_exp_f32 v222, v222
    v_exp_f32 v223, v223
    v_exp_f32 v224, v224
    v_exp_f32 v225, v225
    v_smfmac_f32_32x32x32_bf16 v[160:175], v[144:147], v[216:223], v14
    s_mov_b64 exec, s[46:47]
    ds_read_b128 v[140:143], v17 offset:10880
    ds_read_b128 v[144:147], v17 offset:11456
    s_mov_b64 exec, -1
    s_waitcnt vmcnt(7)
    s_mov_b64 exec, 1
    ds_write_b32 v158, v0 offset:0
    s_mov_b64 exec, -1
    v_exp_f32 v226, v226
    v_exp_f32 v227, v227
    v_exp_f32 v228, v228
    v_exp_f32 v229, v229
    s_waitcnt lgkmcnt(7)
    v_mfma_f32_32x32x4_2b_bf16 v[192:223], v[156:157], v[6:7], 0
    v_exp_f32 v230, v230
    v_exp_f32 v231, v231
    v_exp_f32 v232, v232
    v_exp_f32 v233, v233
    v_exp_f32 v234, v234
    v_exp_f32 v235, v235
    v_exp_f32 v236, v236
    v_exp_f32 v237, v237
    v_smfmac_f32_32x32x32_bf16 v[160:175], v[132:135], v[224:231], v14
    ds_read_b32 v24, v159 offset:0
    v_exp_f32 v238, v238
    v_exp_f32 v239, v239
    v_exp_f32 v240, v240
    v_exp_f32 v241, v241
    v_smfmac_f32_32x32x32_bf16 v[160:175], v[136:139], v[232:239], v14
    s_waitcnt lgkmcnt(0)
L_word_26:
    v_cmp_ne_u32 vcc, s31, v24
    s_cbranch_vccnz L_word_26_r
L_word_26_k:
    s_mov_b64 exec, s[46:47]
    ds_read_b128 v[132:135], v17 offset:19456
    ds_read_b128 v[136:139], v17 offset:20032
    s_mov_b64 exec, -1
    v_exp_f32 v242, v242
    v_exp_f32 v243, v243
    v_exp_f32 v244, v244
    v_exp_f32 v245, v245
    v_mfma_f32_32x32x16_bf16 v[192:207], v[148:151], v[2:5], v[192:207]
    ds_read_b32 v156, v16 offset:29184
    ds_read_b64 v[148:149], v15 offset:29184
    ds_read_b64 v[150:151], v15 offset:29696
    v_exp_f32 v246, v246
    v_exp_f32 v247, v247
    v_exp_f32 v248, v248
    v_exp_f32 v249, v249
    v_smfmac_f32_32x32x32_bf16 v[160:175], v[140:143], v[240:247], v14
    v_exp_f32 v250, v250
    v_exp_f32 v251, v251
    v_exp_f32 v252, v252
    v_exp_f32 v253, v253
    v_mfma_f32_32x32x16_bf16 v[208:223], v[152:155], v[2:5], v[208:223]
    ds_read_b64 v[152:153], v15 offset:29440
    ds_read_b64 v[154:155], v15 offset:29952
    s_waitcnt vmcnt(2)
    s_mov_b64 exec, 1
    ds_write_b32 v158, v0 offset:64
    s_mov_b64 exec, -1
    v_exp_f32 v254, v254
    v_exp_f32 v255, v255
    v_exp_f32 v192, v192
    v_exp_f32 v193, v193
    v_smfmac_f32_32x32x32_bf16 v[160:175], v[144:147], v[248:255], v14
    s_mov_b64 exec, s[46:47]
    ds_read_b128 v[140:143], v17 offset:20608
    ds_read_b128 v[144:147], v17 offset:21184
    s_mov_b64 exec, -1
    v_exp_f32 v194, v194
    v_exp_f32 v195, v195
    v_exp_f32 v196, v196
    v_exp_f32 v197, v197
    s_waitcnt lgkmcnt(7)
    v_mfma_f32_32x32x4_2b_bf16 v[224:255], v[156:157], v[6:7], 0
    s_waitcnt vmcnt(0)
    s_mov_b64 exec, 1
    ds_write_b32 v158, v0 offset:4864
    s_mov_b64 exec, -1
    v_exp_f32 v198, v198
    v_exp_f32 v199, v199
    v_exp_f32 v200, v200
    v_exp_f32 v201, v201
    v_exp_f32 v202, v202
    v_exp_f32 v203, v203
    v_exp_f32 v204, v204
    v_exp_f32 v205, v205
    v_smfmac_f32_32x32x32_bf16 v[160:175], v[132:135], v[192:199], v14
    s_setprio 1
    v_exp_f32 v206, v206
    v_exp_f32 v207, v207
    v_exp_f32 v208, v208
    v_exp_f32 v209, v209
    v_smfmac_f32_32x32x32_bf16 v[160:175], v[136:139], v[200:207], v14
    s_mov_b64 exec, s[46:47]
    ds_read_b128 v[132:135], v17 offset:29184
    ds_read_b128 v[136:139], v17 offset:29760
    s_mov_b64 exec, -1
    ds_read_b32 v24, v159 offset:64
    v_exp_f32 v210, v210
    v_exp_f32 v211, v211
    v_exp_f32 v212, v212
    v_exp_f32 v213, v213
    s_waitcnt lgkmcnt(9)
    v_mfma_f32_32x32x16_bf16 v[224:239], v[148:151], v[2:5], v[224:239]
    s_waitcnt lgkmcnt(0)
L_word_27:
    v_cmp_ne_u32 vcc, s31, v24
    s_cbranch_vccnz L_word_27_r
L_word_27_k:
    ds_read_b32 v156, v16 offset:38912
    ds_read_b64 v[148:149], v15 offset:38912
    ds_read_b64 v[150:151], v15 offset:39424
    v_exp_f32 v214, v214
    v_exp_f32 v215, v215
    v_exp_f32 v216, v216
    v_exp_f32 v217, v217
    v_smfmac_f32_32x32x32_bf16 v[160:175], v[140:143], v[208:215], v14
    v_exp_f32 v218, v218
    v_exp_f32 v219, v219
    v_exp_f32 v220, v220
    v_exp_f32 v221, v221
    v_mfma_f32_32x32x16_bf16 v[240:255], v[152:155], v[2:5], v[240:255]
    ds_read_b64 v[152:153], v15 offset:39168
    ds_read_b64 v[154:155], v15 offset:39680
    v_exp_f32 v222, v222
    v_exp_f32 v223, v223
    v_exp_f32 v224, v224
    v_exp_f32 v225, v225
    v_smfmac_f32_32x32x32_bf16 v[160:175], v[144:147], v[216:223], v14
    s_mov_b64 exec, s[46:47]
    ds_read_b128 v[140:143], v17 offset:30336
    ds_read_b128 v[144:147], v17 offset:30912
    s_mov_b64 exec, -1
    v_exp_f32 v226, v226
    v_exp_f32 v227, v227
    v_exp_f32 v228, v228
    v_exp_f32 v229, v229
    s_waitcnt lgkmcnt(6)
    v_mfma_f32_32x32x4_2b_bf16 v[192:223], v[156:157], v[6:7], 0
    v_exp_f32 v230, v230
    v_exp_f32 v231, v231
    v_exp_f32 v232, v232
    v_exp_f32 v233, v233
    v_exp_f32 v234, v234
    v_exp_f32 v235, v235
    v_exp_f32 v236, v236
    v_exp_f32 v237, v237
    v_smfmac_f32_32x32x32_bf16 v[160:175], v[132:135], v[224:231], v14
    v_exp_f32 v238, v238
    v_exp_f32 v239, v239
    v_exp_f32 v240, v240
    v_exp_f32 v241, v241
    v_smfmac_f32_32x32x32_bf16 v[160:175], v[136:139], v[232:239], v14
    s_mov_b64 exec, s[46:47]
    ds_read_b128 v[132:135], v17 offset:38912
    ds_read_b128 v[136:139], v17 offset:39488
    s_mov_b64 exec, -1
    v_exp_f32 v242, v242
    v_exp_f32 v243, v243
    v_exp_f32 v244, v244
    v_exp_f32 v245, v245
    s_waitcnt lgkmcnt(6)
    v_mfma_f32_32x32x16_bf16 v[192:207], v[148:151], v[2:5], v[192:207]
    ds_read_b32 v156, v16 offset:48640
    ds_read_b64 v[148:149], v15 offset:48640
    ds_read_b64 v[150:151], v15 offset:49152
    v_exp_f32 v246, v246
    v_exp_f32 v247, v247
    v_exp_f32 v248, v248
    v_exp_f32 v249, v249
    s_waitcnt lgkmcnt(5)
    v_smfmac_f32_32x32x32_bf16 v[160:175], v[140:143], v[240:247], v14
    v_exp_f32 v250, v250
    v_exp_f32 v251, v251
    v_exp_f32 v252, v252
    v_exp_f32 v253, v253
    v_mfma_f32_32x32x16_bf16 v[208:223], v[152:155], v[2:5], v[208:223]
    ds_read_b64 v[152:153], v15 offset:48896
    ds_read_b64 v[154:155], v15 offset:49408
    v_exp_f32 v254, v254
    v_exp_f32 v255, v255
    v_exp_f32 v192, v192
    v_exp_f32 v193, v193
    v_smfmac_f32_32x32x32_bf16 v[160:175], v[144:147], v[248:255], v14
    s_mov_b64 exec, s[46:47]
    ds_read_b128 v[140:143], v17 offset:40064
    ds_read_b128 v[144:147], v17 offset:40640
    s_mov_b64 exec, -1
    v_exp_f32 v194, v194
    v_exp_f32 v195, v195
    v_exp_f32 v196, v196
    v_exp_f32 v197, v197
    s_waitcnt lgkmcnt(6)
    v_mfma_f32_32x32x4_2b_bf16 v[224:255], v[156:157], v[6:7], 0
    v_exp_f32 v198, v198
    v_exp_f32 v199, v199
    v_exp_f32 v200, v200
    v_exp_f32 v201, v201
    v_exp_f32 v202, v202
    v_exp_f32 v203, v203
    v_exp_f32 v204, v204
    v_exp_f32 v205, v205
    v_smfmac_f32_32x32x32_bf16 v[160:175], v[132:135], v[192:199], v14
    v_exp_f32 v206, v206
    v_exp_f32 v207, v207
    v_exp_f32 v208, v208
    v_exp_f32 v209, v209
    v_smfmac_f32_32x32x32_bf16 v[160:175], v[136:139], v[200:207], v14
    s_mov_b64 exec, s[46:47]
    ds_read_b128 v[132:135], v17 offset:48640
    ds_read_b128 v[136:139], v17 offset:49216
    s_mov_b64 exec, -1
    v_exp_f32 v210, v210
    v_exp_f32 v211, v211
    v_exp_f32 v212, v212
    v_exp_f32 v213, v213
    s_waitcnt lgkmcnt(6)
    v_mfma_f32_32x32x16_bf16 v[224:239], v[148:151], v[2:5], v[224:239]
    v_add_u32 v16, 0xe400, v16
    ds_read_b32 v156, v16 offset:0
    v_add_u32 v15, 0xe400, v15
    ds_read_b64 v[148:149], v15 offset:0
    ds_read_b64 v[150:151], v15 offset:512
    v_exp_f32 v214, v214
    v_exp_f32 v215, v215
    v_exp_f32 v216, v216
    v_exp_f32 v217, v217
    s_waitcnt lgkmcnt(5)
    v_smfmac_f32_32x32x32_bf16 v[160:175], v[140:143], v[208:215], v14
    v_exp_f32 v218, v218
    v_exp_f32 v219, v219
    v_exp_f32 v220, v220
    v_exp_f32 v221, v221
    v_mfma_f32_32x32x16_bf16 v[240:255], v[152:155], v[2:5], v[240:255]
    ds_read_b64 v[152:153], v15 offset:256
    ds_read_b64 v[154:155], v15 offset:768
    v_exp_f32 v222, v222
    v_exp_f32 v223, v223
    v_exp_f32 v224, v224
    v_exp_f32 v225, v225
    v_smfmac_f32_32x32x32_bf16 v[160:175], v[144:147], v[216:223], v14
    s_mov_b64 exec, s[46:47]
    ds_read_b128 v[140:143], v17 offset:49792
    ds_read_b128 v[144:147], v17 offset:50368
    s_mov_b64 exec, -1
    buffer_load_dword v39, v38, s[20:23], 0 offen offset:4 sc1
    v_exp_f32 v226, v226
    v_exp_f32 v227, v227
    v_exp_f32 v228, v228
    v_exp_f32 v229, v229
    s_waitcnt lgkmcnt(6)
    v_mfma_f32_32x32x4_2b_bf16 v[192:223], v[156:157], v[6:7], 0
    v_exp_f32 v230, v230
    v_exp_f32 v231, v231
    v_exp_f32 v232, v232
    v_exp_f32 v233, v233
    v_exp_f32 v234, v234
    v_exp_f32 v235, v235
    v_exp_f32 v236, v236
    v_exp_f32 v237, v237
    v_smfmac_f32_32x32x32_bf16 v[160:175], v[132:135], v[224:231], v14
    v_exp_f32 v238, v238
    v_exp_f32 v239, v239
    v_exp_f32 v240, v240
    v_exp_f32 v241, v241
    v_smfmac_f32_32x32x32_bf16 v[160:175], v[136:139], v[232:239], v14
    v_add_u32 v17, 0xe400, v17
    s_mov_b64 exec, s[46:47]
    ds_read_b128 v[132:135], v17 offset:0
    ds_read_b128 v[136:139], v17 offset:576
    s_mov_b64 exec, -1
    v_exp_f32 v242, v242
    v_exp_f32 v243, v243
    v_exp_f32 v244, v244
    v_exp_f32 v245, v245
    s_waitcnt lgkmcnt(6)
    v_mfma_f32_32x32x16_bf16 v[192:207], v[148:151], v[2:5], v[192:207]
    ds_read_b32 v156, v16 offset:9728
    ds_read_b64 v[148:149], v15 offset:9728
    ds_read_b64 v[150:151], v15 offset:10240
    v_exp_f32 v246, v246
    v_exp_f32 v247, v247
    v_exp_f32 v248, v248
    v_exp_f32 v249, v249
    s_waitcnt lgkmcnt(5)
    v_smfmac_f32_32x32x32_bf16 v[160:175], v[140:143], v[240:247], v14
    v_exp_f32 v250, v250
    v_exp_f32 v251, v251
    v_exp_f32 v252, v252
    v_exp_f32 v253, v253
    v_mfma_f32_32x32x16_bf16 v[208:223], v[152:155], v[2:5], v[208:223]
    ds_read_b64 v[152:153], v15 offset:9984
    ds_read_b64 v[154:155], v15 offset:10496
    v_exp_f32 v254, v254
    v_exp_f32 v255, v255
    v_exp_f32 v192, v192
    v_exp_f32 v193, v193
    v_smfmac_f32_32x32x32_bf16 v[160:175], v[144:147], v[248:255], v14
    s_mov_b64 exec, s[46:47]
    ds_read_b128 v[140:143], v17 offset:1152
    ds_read_b128 v[144:147], v17 offset:1728
    s_mov_b64 exec, -1
    v_exp_f32 v194, v194
    v_exp_f32 v195, v195
    v_exp_f32 v196, v196
    v_exp_f32 v197, v197
    s_waitcnt lgkmcnt(6)
    v_mfma_f32_32x32x4_2b_bf16 v[224:255], v[156:157], v[6:7], 0
    v_exp_f32 v198, v198
    v_exp_f32 v199, v199
    v_exp_f32 v200, v200
    v_exp_f32 v201, v201
    v_exp_f32 v202, v202
    v_exp_f32 v203, v203
    v_exp_f32 v204, v204
    v_exp_f32 v205, v205
    v_smfmac_f32_32x32x32_bf16 v[160:175], v[132:135], v[192:199], v14
    s_setprio 0
    v_exp_f32 v206, v206
    v_exp_f32 v207, v207
    v_exp_f32 v208, v208
    v_exp_f32 v209, v209
    v_smfmac_f32_32x32x32_bf16 v[160:175], v[136:139], v[200:207], v14
    s_mov_b64 exec, s[46:47]
    ds_read_b128 v[132:135], v17 offset:9728
    ds_read_b128 v[136:139], v17 offset:10304
    s_mov_b64 exec, -1
    s_waitcnt vmcnt(0)
L_poll_28:
    v_cmp_ne_u32 vcc, s31, v39
    s_cbranch_vccnz L_poll_28_r
L_poll_28_k:
    s_add_u32 s60, s51, 3540992
    buffer_load_dwordx2 v[8:9], v22, s[20:23], s60 offen sc1
    buffer_load_dwordx2 v[10:11], v22, s[20:23], s60 offen offset:512 sc1
    buffer_load_dword v12, v23, s[20:23], s60 offen sc1
    s_add_u32 m0, s45, 77824
    s_add_u32 s50, s50, 1770496
    buffer_load_dwordx4 v18, s[20:23], s50 offen offset:0 sc1 lds
    v_exp_f32 v210, v210
    v_exp_f32 v211, v211
    v_exp_f32 v212, v212
    v_exp_f32 v213, v213
    s_waitcnt lgkmcnt(6)
    v_mfma_f32_32x32x16_bf16 v[224:239], v[148:151], v[2:5], v[224:239]
    buffer_load_dwordx4 v18, s[20:23], s50 offen offset:1024 sc1 lds
    buffer_load_dwordx4 v19, s[20:23], s50 offen offset:2048 sc1 lds
    v_exp_f32 v214, v214
    v_exp_f32 v215, v215
    v_exp_f32 v216, v216
    v_exp_f32 v217, v217
    s_waitcnt lgkmcnt(2)
    v_smfmac_f32_32x32x32_bf16 v[160:175], v[140:143], v[208:215], v14
    buffer_load_dwordx4 v20, s[20:23], s50 offen offset:3072 sc1 lds
    s_add_u32 m0, m0, 4096
    s_mov_b64 exec, s[48:49]
    buffer_load_dwordx4 v21, s[20:23], s50 offen sc1 lds
    s_mov_b64 exec, -1
    v_exp_f32 v218, v218
    v_exp_f32 v219, v219
    v_exp_f32 v220, v220
    v_exp_f32 v221, v221
    v_mfma_f32_32x32x16_bf16 v[240:255], v[152:155], v[2:5], v[240:255]
    v_exp_f32 v222, v222
    v_exp_f32 v223, v223
    v_exp_f32 v224, v224
    v_exp_f32 v225, v225
    v_smfmac_f32_32x32x32_bf16 v[160:175], v[144:147], v[216:223], v14
    s_mov_b64 exec, s[46:47]
    ds_read_b128 v[140:143], v17 offset:10880
    ds_read_b128 v[144:147], v17 offset:11456
    s_mov_b64 exec, -1
    v_exp_f32 v226, v226
    v_exp_f32 v227, v227
    v_exp_f32 v228, v228
    v_exp_f32 v229, v229
    s_waitcnt vmcnt(5)
    v_mfma_f32_32x32x4_2b_bf16 v[192:223], v[156:157], v[12:13], 0
    v_exp_f32 v230, v230
    v_exp_f32 v231, v231
    v_exp_f32 v232, v232
    v_exp_f32 v233, v233
    v_exp_f32 v234, v234
    v_exp_f32 v235, v235
    v_exp_f32 v236, v236
    v_exp_f32 v237, v237
    s_waitcnt lgkmcnt(2)
    v_smfmac_f32_32x32x32_bf16 v[160:175], v[132:135], v[224:231], v14
    v_exp_f32 v238, v238
    v_exp_f32 v239, v239
    v_exp_f32 v240, v240
    v_exp_f32 v241, v241
    v_smfmac_f32_32x32x32_bf16 v[160:175], v[136:139], v[232:239], v14
    v_exp_f32 v242, v242
    v_exp_f32 v243, v243
    v_exp_f32 v244, v244
    v_exp_f32 v245, v245
    v_mfma_f32_32x32x16_bf16 v[192:207], v[148:151], v[8:11], v[192:207]
    ds_read_b32 v156, v16 offset:0
    ds_read_b64 v[148:149], v15 offset:0
    ds_read_b64 v[150:151], v15 offset:512
    s_setprio 3
    v_exp_f32 v246, v246
    v_exp_f32 v247, v247
    v_exp_f32 v248, v248
    v_exp_f32 v249, v249
    s_waitcnt lgkmcnt(3)
    v_smfmac_f32_32x32x32_bf16 v[160:175], v[140:143], v[240:247], v14
    v_exp_f32 v250, v250
    v_exp_f32 v251, v251
    v_exp_f32 v252, v252
    v_exp_f32 v253, v253
    v_mfma_f32_32x32x16_bf16 v[208:223], v[152:155], v[8:11], v[208:223]
    ds_read_b64 v[152:153], v15 offset:256
    ds_read_b64 v[154:155], v15 offset:768
    v_exp_f32 v254, v254
    v_exp_f32 v255, v255
    v_exp_f32 v192, v192
    v_exp_f32 v193, v193
    v_smfmac_f32_32x32x32_bf16 v[160:175], v[144:147], v[248:255], v14
    s_waitcnt vmcnt(0)
    s_mov_b64 exec, 1
    ds_write_b32 v158, v0 offset:128
    s_mov_b64 exec, -1
    v_exp_f32 v194, v194
    v_exp_f32 v195, v195
    v_exp_f32 v196, v196
    v_exp_f32 v197, v197
    s_waitcnt lgkmcnt(5)
    v_mfma_f32_32x32x4_2b_bf16 v[224:255], v[156:157], v[12:13], 0
    v_exp_f32 v198, v198
    v_exp_f32 v199, v199
    v_exp_f32 v200, v200
    v_exp_f32 v201, v201
    v_exp_f32 v202, v202
    v_exp_f32 v203, v203
    v_exp_f32 v204, v204
    v_exp_f32 v205, v205
    v_smfmac_f32_32x32x32_bf16 v[176:191], v[132:135], v[192:199], v14
    v_exp_f32 v206, v206
    v_exp_f32 v207, v207
    v_exp_f32 v208, v208
    v_exp_f32 v209, v209
    v_smfmac_f32_32x32x32_bf16 v[176:191], v[136:139], v[200:207], v14
    s_mov_b64 exec, s[46:47]
    ds_read_b128 v[132:135], v17 offset:0
    ds_read_b128 v[136:139], v17 offset:576
    s_mov_b64 exec, -1
    ds_read_b32 v24, v159 offset:128
    v_exp_f32 v210, v210
    v_exp_f32 v211, v211
    v_exp_f32 v212, v212
    v_exp_f32 v213, v213
    s_waitcnt lgkmcnt(6)
    v_mfma_f32_32x32x16_bf16 v[224:239], v[148:151], v[8:11], v[224:239]
    s_waitcnt lgkmcnt(0)
L_word_29:
    v_cmp_ne_u32 vcc, s31, v24
    s_cbranch_vccnz L_word_29_r
L_word_29_k:
    ds_read_b32 v156, v16 offset:19456
    ds_read_b64 v[148:149], v15 offset:19456
    ds_read_b64 v[150:151], v15 offset:19968
    v_exp_f32 v214, v214
    v_exp_f32 v215, v215
    v_exp_f32 v216, v216
    v_exp_f32 v217, v217
    v_smfmac_f32_32x32x32_bf16 v[176:191], v[140:143], v[208:215], v14
    s_add_u32 m0, s45, 116736
    s_add_u32 s50, s50, 1770496
    buffer_load_dwordx4 v18, s[20:23], s50 offen offset:0 sc1 lds
    v_exp_f32 v218, v218
    v_exp_f32 v219, v219
    v_exp_f32 v220, v220
    v_exp_f32 v221, v221
    v_mfma_f32_32x32x16_bf16 v[240:255], v[152:155], v[8:11], v[240:255]
    ds_read_b64 v[152:153], v15 offset:19712
    ds_read_b64 v[154:155], v15 offset:20224
    buffer_load_dwordx4 v18, s[20:23], s50 offen offset:1024 sc1 lds
    v_exp_f32 v222, v222
    v_exp_f32 v223, v223
    v_exp_f32 v224, v224
    v_exp_f32 v225, v225
    v_smfmac_f32_32x32x32_bf16 v[176:191], v[144:147], v[216:223], v14
    s_mov_b64 exec, s[46:47]
    ds_read_b128 v[140:143], v17 offset:1152
    ds_read_b128 v[144:147], v17 offset:1728
    s_mov_b64 exec, -1
    buffer_load_dwordx4 v19, s[20:23], s50 offen offset:2048 sc1 lds
    v_exp_f32 v226, v226
    v_exp_f32 v227, v227
    v_exp_f32 v228, v228
    v_exp_f32 v229, v229
    s_waitcnt lgkmcnt(6)
    v_mfma_f32_32x32x4_2b_bf16 v[192:223], v[156:157], v[6:7], 0
    buffer_load_dwordx4 v20, s[20:23], s50 offen offset:3072 sc1 lds
    v_exp_f32 v230, v230
    v_exp_f32 v231, v231
    v_exp_f32 v232, v232
    v_exp_f32 v233, v233
    v_exp_f32 v234, v234
    v_exp_f32 v235, v235
    v_exp_f32 v236, v236
    v_exp_f32 v237, v237
    v_smfmac_f32_32x32x32_bf16 v[176:191], v[132:135], v[224:231], v14
    s_add_u32 m0, m0, 4096
    s_mov_b64 exec, s[48:49]
    buffer_load_dwordx4 v21, s[20:23], s50 offen sc1 lds
    s_mov_b64 exec, -1
    v_exp_f32 v238, v238
    v_exp_f32 v239, v239
    v_exp_f32 v240, v240
    v_exp_f32 v241, v241
    v_smfmac_f32_32x32x32_bf16 v[176:191], v[136:139], v[232:239], v14
    s_mov_b64 exec, s[46:47]
    ds_read_b128 v[132:135], v17 offset:19456
    ds_read_b128 v[136:139], v17 offset:20032
    s_mov_b64 exec, -1
    v_exp_f32 v242, v242
    v_exp_f32 v243, v243
    v_exp_f32 v244, v244
    v_exp_f32 v245, v245
    s_waitcnt lgkmcnt(6)
    v_mfma_f32_32x32x16_bf16 v[192:207], v[148:151], v[2:5], v[192:207]
    v_exp_f32 v246, v246
    v_exp_f32 v247, v247
    v_exp_f32 v248, v248
    v_exp_f32 v249, v249
    s_waitcnt lgkmcnt(2)
    v_smfmac_f32_32x32x32_bf16 v[176:191], v[140:143], v[240:247], v14
    v_exp_f32 v250, v250
    v_exp_f32 v251, v251
    v_exp_f32 v252, v252
    v_exp_f32 v253, v253
    v_mfma_f32_32x32x16_bf16 v[208:223], v[152:155], v[2:5], v[208:223]
    v_exp_f32 v254, v254
    v_exp_f32 v255, v255
    v_exp_f32 v192, v192
    v_exp_f32 v193, v193
    v_smfmac_f32_32x32x32_bf16 v[176:191], v[144:147], v[248:255], v14
    s_mov_b64 exec, s[46:47]
    ds_read_b128 v[140:143], v17 offset:20608
    ds_read_b128 v[144:147], v17 offset:21184
    s_mov_b64 exec, -1
    v_exp_f32 v194, v194
    v_exp_f32 v195, v195
    v_exp_f32 v196, v196
    v_exp_f32 v197, v197
    v_mfma_f32_32x32x4_2b_bf16 v[224:255], v[156:157], v[12:13], 0
    v_exp_f32 v198, v198
    v_exp_f32 v199, v199
    v_exp_f32 v200, v200
    v_exp_f32 v201, v201
    v_exp_f32 v202, v202
    v_exp_f32 v203, v203
    v_exp_f32 v204, v204
    v_exp_f32 v205, v205
    s_waitcnt lgkmcnt(2)
    v_smfmac_f32_32x32x32_bf16 v[160:175], v[132:135], v[192:199], v14
    v_mov_b64 v[114:115], -1
    v_mov_b64 v[116:117], -1
    v_mov_b32 v118, -1
    v_lshlrev_b32 v24, 2, v1
    s_add_u32 s61, s34, 1183744
    s_add_u32 s62, s3, 1183744
    buffer_store_dwordx4 v[114:117], v40, s[20:23], s61 offen sc1
    s_mov_b32 exec_hi, 0
    buffer_store_dword v118, v24, s[20:23], s62 offen sc1
    s_mov_b64 exec, -1
    v_mov_b64 v[24:25], 0
    s_mov_b64 exec, 0xff
    buffer_store_dwordx4 v[24:27], v40, s[20:23], s15 offen sc1
    s_mov_b64 exec, -1
    v_exp_f32 v206, v206
    v_exp_f32 v207, v207
    v_exp_f32 v208, v208
    v_exp_f32 v209, v209
    v_smfmac_f32_32x32x32_bf16 v[160:175], v[136:139], v[200:207], v14
    v_exp_f32 v210, v210
    v_exp_f32 v211, v211
    v_exp_f32 v212, v212
    v_exp_f32 v213, v213
    v_mfma_f32_32x32x16_bf16 v[224:239], v[148:151], v[8:11], v[224:239]
    ds_read_b32 v156, v16 offset:29184
    ds_read_b64 v[148:149], v15 offset:29184
    ds_read_b64 v[150:151], v15 offset:29696
    v_exp_f32 v214, v214
    v_exp_f32 v215, v215
    v_exp_f32 v216, v216
    v_exp_f32 v217, v217
    s_waitcnt lgkmcnt(3)
    v_smfmac_f32_32x32x32_bf16 v[160:175], v[140:143], v[208:215], v14
    v_exp_f32 v218, v218
    v_exp_f32 v219, v219
    v_exp_f32 v220, v220
    v_exp_f32 v221, v221
    v_mfma_f32_32x32x16_bf16 v[240:255], v[152:155], v[8:11], v[240:255]
    ds_read_b64 v[152:153], v15 offset:29440
    ds_read_b64 v[154:155], v15 offset:29952
    v_exp_f32 v222, v222
    v_exp_f32 v223, v223
    v_exp_f32 v224, v224
    v_exp_f32 v225, v225
    v_smfmac_f32_32x32x32_bf16 v[160:175], v[144:147], v[216:223], v14
    v_exp_f32 v226, v226
    v_exp_f32 v227, v227
    v_exp_f32 v228, v228
    v_exp_f32 v229, v229
    s_waitcnt lgkmcnt(4)
    v_mfma_f32_32x32x4_2b_bf16 v[192:223], v[156:157], v[6:7], 0
    v_exp_f32 v230, v230
    v_exp_f32 v231, v231
    v_exp_f32 v232, v232
    v_exp_f32 v233, v233
    v_exp_f32 v234, v234
    v_exp_f32 v235, v235
    v_exp_f32 v236, v236
    v_exp_f32 v237, v237
    v_smfmac_f32_32x32x32_bf16 v[176:191], v[132:135], v[224:231], v14
    v_exp_f32 v238, v238
    v_exp_f32 v239, v239
    v_exp_f32 v240, v240
    v_exp_f32 v241, v241
    v_smfmac_f32_32x32x32_bf16 v[176:191], v[136:139], v[232:239], v14
    s_mov_b64 exec, s[46:47]
    ds_read_b128 v[132:135], v17 offset:29184
    ds_read_b128 v[136:139], v17 offset:29760
    s_mov_b64 exec, -1
    v_exp_f32 v242, v242
    v_exp_f32 v243, v243
    v_exp_f32 v244, v244
    v_exp_f32 v245, v245
    s_waitcnt lgkmcnt(4)
    v_mfma_f32_32x32x16_bf16 v[192:207], v[148:151], v[2:5], v[192:207]
    v_exp_f32 v246, v246
    v_exp_f32 v247, v247
    v_exp_f32 v248, v248
    v_exp_f32 v249, v249
    v_smfmac_f32_32x32x32_bf16 v[176:191], v[140:143], v[240:247], v14
    v_exp_f32 v250, v250
    v_exp_f32 v251, v251
    v_exp_f32 v252, v252
    v_exp_f32 v253, v253
    s_waitcnt lgkmcnt(2)
    v_mfma_f32_32x32x16_bf16 v[208:223], v[152:155], v[2:5], v[208:223]
    v_exp_f32 v254, v254
    v_exp_f32 v255, v255
    v_exp_f32 v192, v192
    v_exp_f32 v193, v193
    v_smfmac_f32_32x32x32_bf16 v[176:191], v[144:147], v[248:255], v14
    s_mov_b64 exec, s[46:47]
    ds_read_b128 v[140:143], v17 offset:30336
    ds_read_b128 v[144:147], v17 offset:30912
    s_mov_b64 exec, -1
    v_exp_f32 v194, v194
    v_exp_f32 v195, v195
    v_exp_f32 v196, v196
    v_exp_f32 v197, v197
    v_mfma_f32_32x32x4_2b_bf16 v[224:255], v[156:157], v[12:13], 0
    v_exp_f32 v198, v198
    v_exp_f32 v199, v199
    v_exp_f32 v200, v200
    v_exp_f32 v201, v201
    v_exp_f32 v202, v202
    v_exp_f32 v203, v203
    v_exp_f32 v204, v204
    v_exp_f32 v205, v205
    s_waitcnt lgkmcnt(2)
    v_smfmac_f32_32x32x32_bf16 v[160:175], v[132:135], v[192:199], v14
    v_exp_f32 v206, v206
    v_exp_f32 v207, v207
    v_exp_f32 v208, v208
L_pad5:
    s_cbranch_execz L_warm_ret
    v_exp_f32 v209, v209
    v_smfmac_f32_32x32x32_bf16 v[160:175], v[136:139], v[200:207], v14
    v_exp_f32 v210, v210
    v_exp_f32 v211, v211
    v_exp_f32 v212, v212
    v_exp_f32 v213, v213
    v_mfma_f32_32x32x16_bf16 v[224:239], v[148:151], v[8:11], v[224:239]
    ds_read_b32 v156, v16 offset:38912
    ds_read_b64 v[148:149], v15 offset:38912
    ds_read_b64 v[150:151], v15 offset:39424
    v_exp_f32 v214, v214
    v_exp_f32 v215, v215
    v_exp_f32 v216, v216
    v_exp_f32 v217, v217
    s_waitcnt lgkmcnt(3)
    v_smfmac_f32_32x32x32_bf16 v[160:175], v[140:143], v[208:215], v14
    v_exp_f32 v218, v218
    v_exp_f32 v219, v219
    v_exp_f32 v220, v220
    v_exp_f32 v221, v221
    v_mfma_f32_32x32x16_bf16 v[240:255], v[152:155], v[8:11], v[240:255]
    ds_read_b64 v[152:153], v15 offset:39168
    ds_read_b64 v[154:155], v15 offset:39680
    v_exp_f32 v222, v222
    v_exp_f32 v223, v223
    v_exp_f32 v224, v224
    v_exp_f32 v225, v225
    v_smfmac_f32_32x32x32_bf16 v[160:175], v[144:147], v[216:223], v14
    v_exp_f32 v226, v226
    v_exp_f32 v227, v227
    v_exp_f32 v228, v228
    v_exp_f32 v229, v229
    s_waitcnt lgkmcnt(4)
    v_mfma_f32_32x32x4_2b_bf16 v[192:223], v[156:157], v[6:7], 0
    v_exp_f32 v230, v230
    v_exp_f32 v231, v231
    v_exp_f32 v232, v232
    v_exp_f32 v233, v233
    v_exp_f32 v234, v234
    v_exp_f32 v235, v235
    v_exp_f32 v236, v236
    v_exp_f32 v237, v237
    v_smfmac_f32_32x32x32_bf16 v[176:191], v[132:135], v[224:231], v14
    s_waitcnt vmcnt(3)
    s_mov_b64 exec, 1
    ds_write_b32 v158, v0 offset:192
    s_mov_b64 exec, -1
    v_exp_f32 v238, v238
    v_exp_f32 v239, v239
    v_exp_f32 v240, v240
    v_exp_f32 v241, v241
    v_smfmac_f32_32x32x32_bf16 v[176:191], v[136:139], v[232:239], v14
    s_mov_b64 exec, s[46:47]
    ds_read_b128 v[132:135], v17 offset:38912
    ds_read_b128 v[136:139], v17 offset:39488
    s_mov_b64 exec, -1
    v_exp_f32 v242, v242
    v_exp_f32 v243, v243
    v_exp_f32 v244, v244
    v_exp_f32 v245, v245
    s_waitcnt lgkmcnt(5)
    v_mfma_f32_32x32x16_bf16 v[192:207], v[148:151], v[2:5], v[192:207]
    v_exp_f32 v246, v246
    v_exp_f32 v247, v247
    v_exp_f32 v248, v248
    v_exp_f32 v249, v249
    v_smfmac_f32_32x32x32_bf16 v[176:191], v[140:143], v[240:247], v14
    v_exp_f32 v250, v250
    v_exp_f32 v251, v251
    v_exp_f32 v252, v252
    v_exp_f32 v253, v253
    s_waitcnt lgkmcnt(3)
    v_mfma_f32_32x32x16_bf16 v[208:223], v[152:155], v[2:5], v[208:223]
    v_exp_f32 v254, v254
    v_exp_f32 v255, v255
    v_exp_f32 v192, v192
    v_exp_f32 v193, v193
    v_smfmac_f32_32x32x32_bf16 v[176:191], v[144:147], v[248:255], v14
    s_mov_b64 exec, s[46:47]
    ds_read_b128 v[140:143], v17 offset:40064
    ds_read_b128 v[144:147], v17 offset:40640
    s_mov_b64 exec, -1
    v_exp_f32 v194, v194
    v_exp_f32 v195, v195
    v_exp_f32 v196, v196
    v_exp_f32 v197, v197
    v_mfma_f32_32x32x4_2b_bf16 v[224:255], v[156:157], v[12:13], 0
    v_exp_f32 v198, v198
    v_exp_f32 v199, v199
    v_exp_f32 v200, v200
    v_exp_f32 v201, v201
    v_exp_f32 v202, v202
    v_exp_f32 v203, v203
    v_exp_f32 v204, v204
    v_exp_f32 v205, v205
    s_waitcnt lgkmcnt(2)
    v_smfmac_f32_32x32x32_bf16 v[160:175], v[132:135], v[192:199], v14
    v_exp_f32 v206, v206
    v_exp_f32 v207, v207
    v_exp_f32 v208, v208
    v_exp_f32 v209, v209
    v_smfmac_f32_32x32x32_bf16 v[160:175], v[136:139], v[200:207], v14
    v_exp_f32 v210, v210
    v_exp_f32 v211, v211
    v_exp_f32 v212, v212
    v_exp_f32 v213, v213
    v_mfma_f32_32x32x16_bf16 v[224:239], v[148:151], v[8:11], v[224:239]
    ds_read_b32 v156, v16 offset:48640
    ds_read_b64 v[148:149], v15 offset:48640
    ds_read_b64 v[150:151], v15 offset:49152
    v_exp_f32 v214, v214
    v_exp_f32 v215, v215
    v_exp_f32 v216, v216
    v_exp_f32 v217, v217
    s_waitcnt lgkmcnt(3)
    v_smfmac_f32_32x32x32_bf16 v[160:175], v[140:143], v[208:215], v14
    v_exp_f32 v218, v218
    v_exp_f32 v219, v219
    v_exp_f32 v220, v220
    v_exp_f32 v221, v221
    v_mfma_f32_32x32x16_bf16 v[240:255], v[152:155], v[8:11], v[240:255]
    ds_read_b64 v[152:153], v15 offset:48896
    ds_read_b64 v[154:155], v15 offset:49408
    v_exp_f32 v222, v222
    v_exp_f32 v223, v223
    v_exp_f32 v224, v224
    v_exp_f32 v225, v225
    v_smfmac_f32_32x32x32_bf16 v[160:175], v[144:147], v[216:223], v14
    v_exp_f32 v226, v226
    v_exp_f32 v227, v227
    v_exp_f32 v228, v228
    v_exp_f32 v229, v229
    s_waitcnt lgkmcnt(4)
    v_mfma_f32_32x32x4_2b_bf16 v[192:223], v[156:157], v[6:7], 0
    v_exp_f32 v230, v230
    v_exp_f32 v231, v231
    v_exp_f32 v232, v232
    v_exp_f32 v233, v233
    v_exp_f32 v234, v234
    v_exp_f32 v235, v235
    v_exp_f32 v236, v236
    v_exp_f32 v237, v237
    v_smfmac_f32_32x32x32_bf16 v[176:191], v[132:135], v[224:231], v14
    v_exp_f32 v238, v238
    v_exp_f32 v239, v239
    v_exp_f32 v240, v240
    v_exp_f32 v241, v241
    v_smfmac_f32_32x32x32_bf16 v[176:191], v[136:139], v[232:239], v14
    s_mov_b64 exec, s[46:47]
    ds_read_b128 v[132:135], v17 offset:48640
    ds_read_b128 v[136:139], v17 offset:49216
    s_mov_b64 exec, -1
    v_exp_f32 v242, v242
    v_exp_f32 v243, v243
    v_exp_f32 v244, v244
    v_exp_f32 v245, v245
    s_waitcnt lgkmcnt(4)
    v_mfma_f32_32x32x16_bf16 v[192:207], v[148:151], v[2:5], v[192:207]
    v_exp_f32 v246, v246
    v_exp_f32 v247, v247
    v_exp_f32 v248, v248
    v_exp_f32 v249, v249
    v_smfmac_f32_32x32x32_bf16 v[176:191], v[140:143], v[240:247], v14
    v_exp_f32 v250, v250
    v_exp_f32 v251, v251
    v_exp_f32 v252, v252
    v_exp_f32 v253, v253
    s_waitcnt lgkmcnt(2)
    v_mfma_f32_32x32x16_bf16 v[208:223], v[152:155], v[2:5], v[208:223]
    v_exp_f32 v254, v254
    v_exp_f32 v255, v255
    v_exp_f32 v192, v192
    v_exp_f32 v193, v193
    v_smfmac_f32_32x32x32_bf16 v[176:191], v[144:147], v[248:255], v14
    s_mov_b64 exec, s[46:47]
    ds_read_b128 v[140:143], v17 offset:49792
    ds_read_b128 v[144:147], v17 offset:50368
    s_mov_b64 exec, -1
    v_exp_f32 v194, v194
    v_exp_f32 v195, v195
    v_exp_f32 v196, v196
    v_exp_f32 v197, v197
    v_mfma_f32_32x32x4_2b_bf16 v[224:255], v[156:157], v[12:13], 0
    v_exp_f32 v198, v198
    v_exp_f32 v199, v199
    v_exp_f32 v200, v200
    v_exp_f32 v201, v201
    v_exp_f32 v202, v202
    v_exp_f32 v203, v203
    v_exp_f32 v204, v204
    v_exp_f32 v205, v205
    s_waitcnt lgkmcnt(2)
    v_smfmac_f32_32x32x32_bf16 v[160:175], v[132:135], v[192:199], v14
    v_exp_f32 v206, v206
    v_exp_f32 v207, v207
    v_exp_f32 v208, v208
    v_exp_f32 v209, v209
    v_smfmac_f32_32x32x32_bf16 v[160:175], v[136:139], v[200:207], v14
    ds_read_b32 v24, v159 offset:192
    v_exp_f32 v210, v210
    v_exp_f32 v211, v211
    v_exp_f32 v212, v212
    v_exp_f32 v213, v213
    v_mfma_f32_32x32x16_bf16 v[224:239], v[148:151], v[8:11], v[224:239]
    s_waitcnt lgkmcnt(0)
L_word_30:
    v_cmp_ne_u32 vcc, s31, v24
    s_cbranch_vccnz L_word_30_r
L_word_30_k:
    v_add_u32 v16, 0xe400, v16
    ds_read_b32 v156, v16 offset:0
    v_add_u32 v15, 0xe400, v15
    ds_read_b64 v[148:149], v15 offset:0
    ds_read_b64 v[150:151], v15 offset:512
    v_exp_f32 v214, v214
    v_exp_f32 v215, v215
    v_exp_f32 v216, v216
    v_exp_f32 v217, v217
    v_smfmac_f32_32x32x32_bf16 v[160:175], v[140:143], v[208:215], v14
    v_exp_f32 v218, v218
    v_exp_f32 v219, v219
    v_exp_f32 v220, v220
    v_exp_f32 v221, v221
    v_mfma_f32_32x32x16_bf16 v[240:255], v[152:155], v[8:11], v[240:255]
    ds_read_b64 v[152:153], v15 offset:256
    ds_read_b64 v[154:155], v15 offset:768
    v_exp_f32 v222, v222
    v_exp_f32 v223, v223
    v_exp_f32 v224, v224
    v_exp_f32 v225, v225
    v_smfmac_f32_32x32x32_bf16 v[160:175], v[144:147], v[216:223], v14
    v_exp_f32 v226, v226
    v_exp_f32 v227, v227
    v_exp_f32 v228, v228
    v_exp_f32 v229, v229
    s_waitcnt lgkmcnt(4)
    v_mfma_f32_32x32x4_2b_bf16 v[192:223], v[156:157], v[6:7], 0
    v_exp_f32 v230, v230
    v_exp_f32 v231, v231
    v_exp_f32 v232, v232
    v_exp_f32 v233, v233
    v_exp_f32 v234, v234
    v_exp_f32 v235, v235
    v_exp_f32 v236, v236
    v_exp_f32 v237, v237
    v_smfmac_f32_32x32x32_bf16 v[176:191], v[132:135], v[224:231], v14
    v_exp_f32 v238, v238
    v_exp_f32 v239, v239
    v_exp_f32 v240, v240
    v_exp_f32 v241, v241
    v_smfmac_f32_32x32x32_bf16 v[176:191], v[136:139], v[232:239], v14
    v_add_u32 v17, 0xe400, v17
    s_mov_b64 exec, s[46:47]
    ds_read_b128 v[132:135], v17 offset:0
    ds_read_b128 v[136:139], v17 offset:576
    s_mov_b64 exec, -1
    v_exp_f32 v242, v242
    v_exp_f32 v243, v243
    v_exp_f32 v244, v244
    v_exp_f32 v245, v245
    s_waitcnt lgkmcnt(4)
    v_mfma_f32_32x32x16_bf16 v[192:207], v[148:151], v[2:5], v[192:207]
    v_exp_f32 v246, v246
    v_exp_f32 v247, v247
    v_exp_f32 v248, v248
    v_exp_f32 v249, v249
    v_smfmac_f32_32x32x32_bf16 v[176:191], v[140:143], v[240:247], v14
    v_exp_f32 v250, v250
    v_exp_f32 v251, v251
    v_exp_f32 v252, v252
    v_exp_f32 v253, v253
    s_waitcnt lgkmcnt(2)
    v_mfma_f32_32x32x16_bf16 v[208:223], v[152:155], v[2:5], v[208:223]
    v_exp_f32 v254, v254
    v_exp_f32 v255, v255
    v_exp_f32 v192, v192
    v_exp_f32 v193, v193
    v_smfmac_f32_32x32x32_bf16 v[176:191], v[144:147], v[248:255], v14
    s_mov_b64 exec, s[46:47]
    ds_read_b128 v[140:143], v17 offset:1152
    ds_read_b128 v[144:147], v17 offset:1728
    s_mov_b64 exec, -1
    v_exp_f32 v194, v194
    v_exp_f32 v195, v195
    v_exp_f32 v196, v196
    v_exp_f32 v197, v197
    v_mfma_f32_32x32x4_2b_bf16 v[224:255], v[156:157], v[12:13], 0
    v_exp_f32 v198, v198
    v_exp_f32 v199, v199
    v_exp_f32 v200, v200
    v_exp_f32 v201, v201
    v_exp_f32 v202, v202
    v_exp_f32 v203, v203
    v_exp_f32 v204, v204
    v_exp_f32 v205, v205
    s_waitcnt lgkmcnt(2)
    v_smfmac_f32_32x32x32_bf16 v[160:175], v[132:135], v[192:199], v14
    v_exp_f32 v206, v206
    v_exp_f32 v207, v207
    v_exp_f32 v208, v208
    v_exp_f32 v209, v209
    v_smfmac_f32_32x32x32_bf16 v[160:175], v[136:139], v[200:207], v14
    v_exp_f32 v210, v210
    v_exp_f32 v211, v211
    v_exp_f32 v212, v212
    v_exp_f32 v213, v213
    v_mfma_f32_32x32x16_bf16 v[224:239], v[148:151], v[8:11], v[224:239]
    ds_read_b32 v156, v16 offset:9728
    ds_read_b64 v[148:149], v15 offset:9728
    ds_read_b64 v[150:151], v15 offset:10240
    v_exp_f32 v214, v214
    v_exp_f32 v215, v215
    v_exp_f32 v216, v216
    v_exp_f32 v217, v217
    s_waitcnt lgkmcnt(3)
    v_smfmac_f32_32x32x32_bf16 v[160:175], v[140:143], v[208:215], v14
    v_exp_f32 v218, v218
    v_exp_f32 v219, v219
    v_exp_f32 v220, v220
    v_exp_f32 v221, v221
    v_mfma_f32_32x32x16_bf16 v[240:255], v[152:155], v[8:11], v[240:255]
    ds_read_b64 v[152:153], v15 offset:9984
    ds_read_b64 v[154:155], v15 offset:10496
    v_exp_f32 v222, v222
    v_exp_f32 v223, v223
    v_exp_f32 v224, v224
    v_exp_f32 v225, v225
    v_smfmac_f32_32x32x32_bf16 v[160:175], v[144:147], v[216:223], v14
    v_exp_f32 v226, v226
    v_exp_f32 v227, v227
    v_exp_f32 v228, v228
    v_exp_f32 v229, v229
    s_waitcnt lgkmcnt(4)
    v_mfma_f32_32x32x4_2b_bf16 v[192:223], v[156:157], v[6:7], 0
    v_exp_f32 v230, v230
    v_exp_f32 v231, v231
    v_exp_f32 v232, v232
    v_exp_f32 v233, v233
    v_exp_f32 v234, v234
    v_exp_f32 v235, v235
    v_exp_f32 v236, v236
    v_exp_f32 v237, v237
    v_smfmac_f32_32x32x32_bf16 v[176:191], v[132:135], v[224:231], v14
    v_exp_f32 v238, v238
    v_exp_f32 v239, v239
    v_exp_f32 v240, v240
    v_exp_f32 v241, v241
    v_smfmac_f32_32x32x32_bf16 v[176:191], v[136:139], v[232:239], v14
    s_mov_b64 exec, s[46:47]
    ds_read_b128 v[132:135], v17 offset:9728
    ds_read_b128 v[136:139], v17 offset:10304
    s_mov_b64 exec, -1
    v_exp_f32 v242, v242
    v_exp_f32 v243, v243
    v_exp_f32 v244, v244
    v_exp_f32 v245, v245
    s_waitcnt lgkmcnt(4)
    v_mfma_f32_32x32x16_bf16 v[192:207], v[148:151], v[2:5], v[192:207]
    v_exp_f32 v246, v246
    v_exp_f32 v247, v247
    v_exp_f32 v248, v248
    v_exp_f32 v249, v249
    v_smfmac_f32_32x32x32_bf16 v[176:191], v[140:143], v[240:247], v14
    v_exp_f32 v250, v250
    v_exp_f32 v251, v251
    v_exp_f32 v252, v252
    v_exp_f32 v253, v253
    s_waitcnt lgkmcnt(2)
    v_mfma_f32_32x32x16_bf16 v[208:223], v[152:155], v[2:5], v[208:223]
    v_exp_f32 v254, v254
    v_exp_f32 v255, v255
    v_exp_f32 v192, v192
    v_exp_f32 v193, v193
    v_smfmac_f32_32x32x32_bf16 v[176:191], v[144:147], v[248:255], v14
    s_mov_b64 exec, s[46:47]
    ds_read_b128 v[140:143], v17 offset:10880
    ds_read_b128 v[144:147], v17 offset:11456
    s_mov_b64 exec, -1
    v_exp_f32 v194, v194
    v_exp_f32 v195, v195
    v_exp_f32 v196, v196
    v_exp_f32 v197, v197
    v_mfma_f32_32x32x4_2b_bf16 v[224:255], v[156:157], v[12:13], 0
    v_exp_f32 v198, v198
    v_exp_f32 v199, v199
    v_exp_f32 v200, v200
    v_exp_f32 v201, v201
    v_exp_f32 v202, v202
    v_exp_f32 v203, v203
    v_exp_f32 v204, v204
    v_exp_f32 v205, v205
    s_waitcnt lgkmcnt(2)
    v_smfmac_f32_32x32x32_bf16 v[160:175], v[132:135], v[192:199], v14
    v_exp_f32 v206, v206
    v_exp_f32 v207, v207
    v_exp_f32 v208, v208
    v_exp_f32 v209, v209
    v_smfmac_f32_32x32x32_bf16 v[160:175], v[136:139], v[200:207], v14
    v_exp_f32 v210, v210
    v_exp_f32 v211, v211
    v_exp_f32 v212, v212
    v_exp_f32 v213, v213
    v_mfma_f32_32x32x16_bf16 v[224:239], v[148:151], v[8:11], v[224:239]
    ds_read_b32 v156, v16 offset:19456
    ds_read_b64 v[148:149], v15 offset:19456
    ds_read_b64 v[150:151], v15 offset:19968
    v_exp_f32 v214, v214
    v_exp_f32 v215, v215
    v_exp_f32 v216, v216
    v_exp_f32 v217, v217
    s_waitcnt lgkmcnt(3)
    v_smfmac_f32_32x32x32_bf16 v[160:175], v[140:143], v[208:215], v14
    v_exp_f32 v218, v218
    v_exp_f32 v219, v219
    v_exp_f32 v220, v220
    v_exp_f32 v221, v221
    v_mfma_f32_32x32x16_bf16 v[240:255], v[152:155], v[8:11], v[240:255]
    ds_read_b64 v[152:153], v15 offset:19712
    ds_read_b64 v[154:155], v15 offset:20224
    v_exp_f32 v222, v222
    v_exp_f32 v223, v223
    v_exp_f32 v224, v224
    v_exp_f32 v225, v225
    v_smfmac_f32_32x32x32_bf16 v[160:175], v[144:147], v[216:223], v14
    v_exp_f32 v226, v226
    v_exp_f32 v227, v227
    v_exp_f32 v228, v228
    v_exp_f32 v229, v229
    s_waitcnt lgkmcnt(4)
    v_mfma_f32_32x32x4_2b_bf16 v[192:223], v[156:157], v[6:7], 0
    v_exp_f32 v230, v230
    v_exp_f32 v231, v231
    v_exp_f32 v232, v232
    v_exp_f32 v233, v233
    v_exp_f32 v234, v234
    v_exp_f32 v235, v235
    v_exp_f32 v236, v236
    v_exp_f32 v237, v237
    v_smfmac_f32_32x32x32_bf16 v[176:191], v[132:135], v[224:231], v14
    v_exp_f32 v238, v238
    v_exp_f32 v239, v239
    v_exp_f32 v240, v240
    v_exp_f32 v241, v241
    v_smfmac_f32_32x32x32_bf16 v[176:191], v[136:139], v[232:239], v14
    s_mov_b64 exec, s[46:47]
    ds_read_b128 v[132:135], v17 offset:19456
    ds_read_b128 v[136:139], v17 offset:20032
    s_mov_b64 exec, -1
    v_exp_f32 v242, v242
    v_exp_f32 v243, v243
    v_exp_f32 v244, v244
    v_exp_f32 v245, v245
    s_waitcnt lgkmcnt(4)
    v_mfma_f32_32x32x16_bf16 v[192:207], v[148:151], v[2:5], v[192:207]
    v_exp_f32 v246, v246
    v_exp_f32 v247, v247
    v_exp_f32 v248, v248
    v_exp_f32 v249, v249
    v_smfmac_f32_32x32x32_bf16 v[176:191], v[140:143], v[240:247], v14
    v_exp_f32 v250, v250
    v_exp_f32 v251, v251
    v_exp_f32 v252, v252
    v_exp_f32 v253, v253
    s_waitcnt lgkmcnt(2)
    v_mfma_f32_32x32x16_bf16 v[208:223], v[152:155], v[2:5], v[208:223]
    v_exp_f32 v254, v254
    v_exp_f32 v255, v255
    v_exp_f32 v192, v192
    v_exp_f32 v193, v193
    v_smfmac_f32_32x32x32_bf16 v[176:191], v[144:147], v[248:255], v14
    s_mov_b64 exec, s[46:47]
    ds_read_b128 v[140:143], v17 offset:20608
    ds_read_b128 v[144:147], v17 offset:21184
    s_mov_b64 exec, -1
    v_exp_f32 v194, v194
    v_exp_f32 v195, v195
    v_exp_f32 v196, v196
    v_exp_f32 v197, v197
    v_mfma_f32_32x32x4_2b_bf16 v[224:255], v[156:157], v[12:13], 0
    v_exp_f32 v198, v198
    v_exp_f32 v199, v199
    v_exp_f32 v200, v200
    v_exp_f32 v201, v201
    v_exp_f32 v202, v202
    v_exp_f32 v203, v203
    v_exp_f32 v204, v204
    v_exp_f32 v205, v205
    s_waitcnt lgkmcnt(2)
    v_smfmac_f32_32x32x32_bf16 v[160:175], v[132:135], v[192:199], v14
    v_exp_f32 v206, v206
    v_exp_f32 v207, v207
    v_exp_f32 v208, v208
    v_exp_f32 v209, v209
    v_smfmac_f32_32x32x32_bf16 v[160:175], v[136:139], v[200:207], v14
    v_exp_f32 v210, v210
    v_exp_f32 v211, v211
    v_exp_f32 v212, v212
    v_exp_f32 v213, v213
    v_mfma_f32_32x32x16_bf16 v[224:239], v[148:151], v[8:11], v[224:239]
    ds_read_b32 v156, v16 offset:29184
    ds_read_b64 v[148:149], v15 offset:29184
    ds_read_b64 v[150:151], v15 offset:29696
    v_exp_f32 v214, v214
    v_exp_f32 v215, v215
    v_exp_f32 v216, v216
    v_exp_f32 v217, v217
    s_waitcnt lgkmcnt(3)
    v_smfmac_f32_32x32x32_bf16 v[160:175], v[140:143], v[208:215], v14
    v_exp_f32 v218, v218
    v_exp_f32 v219, v219
    v_exp_f32 v220, v220
    v_exp_f32 v221, v221
    v_mfma_f32_32x32x16_bf16 v[240:255], v[152:155], v[8:11], v[240:255]
    ds_read_b64 v[152:153], v15 offset:29440
    ds_read_b64 v[154:155], v15 offset:29952
    v_exp_f32 v222, v222
    v_exp_f32 v223, v223
    v_exp_f32 v224, v224
    v_exp_f32 v225, v225
    v_smfmac_f32_32x32x32_bf16 v[160:175], v[144:147], v[216:223], v14
    v_exp_f32 v226, v226
    v_exp_f32 v227, v227
    v_exp_f32 v228, v228
    v_exp_f32 v229, v229
    s_waitcnt lgkmcnt(4)
    v_mfma_f32_32x32x4_2b_bf16 v[192:223], v[156:157], v[6:7], 0
    v_exp_f32 v230, v230
    v_exp_f32 v231, v231
    v_exp_f32 v232, v232
    v_exp_f32 v233, v233
    v_exp_f32 v234, v234
    v_exp_f32 v235, v235
    v_exp_f32 v236, v236
    v_exp_f32 v237, v237
    v_smfmac_f32_32x32x32_bf16 v[176:191], v[132:135], v[224:231], v14
    v_exp_f32 v238, v238
    v_exp_f32 v239, v239
    v_exp_f32 v240, v240
    v_exp_f32 v241, v241
    v_smfmac_f32_32x32x32_bf16 v[176:191], v[136:139], v[232:239], v14
    s_mov_b64 exec, s[46:47]
    ds_read_b128 v[132:135], v17 offset:29184
    ds_read_b128 v[136:139], v17 offset:29760
    s_mov_b64 exec, -1
    v_exp_f32 v242, v242
    v_exp_f32 v243, v243
    v_exp_f32 v244, v244
    v_exp_f32 v245, v245
    s_waitcnt lgkmcnt(4)
    v_mfma_f32_32x32x16_bf16 v[192:207], v[148:151], v[2:5], v[192:207]
    v_exp_f32 v246, v246
    v_exp_f32 v247, v247
    v_exp_f32 v248, v248
    v_exp_f32 v249, v249
    v_smfmac_f32_32x32x32_bf16 v[176:191], v[140:143], v[240:247], v14
    v_exp_f32 v250, v250
    v_exp_f32 v251, v251
    v_exp_f32 v252, v252
    v_exp_f32 v253, v253
    s_waitcnt lgkmcnt(2)
    v_mfma_f32_32x32x16_bf16 v[208:223], v[152:155], v[2:5], v[208:223]
    v_exp_f32 v254, v254
    v_exp_f32 v255, v255
    v_exp_f32 v192, v192
    v_exp_f32 v193, v193
    v_smfmac_f32_32x32x32_bf16 v[176:191], v[144:147], v[248:255], v14
    s_mov_b64 exec, s[46:47]
    ds_read_b128 v[140:143], v17 offset:30336
    ds_read_b128 v[144:147], v17 offset:30912
    s_mov_b64 exec, -1
    v_exp_f32 v194, v194
    v_exp_f32 v195, v195
    v_exp_f32 v196, v196
    v_exp_f32 v197, v197
    v_mfma_f32_32x32x4_2b_bf16 v[224:255], v[156:157], v[12:13], 0
    v_exp_f32 v198, v198
    v_exp_f32 v199, v199
    v_exp_f32 v200, v200
    v_exp_f32 v201, v201
    v_exp_f32 v202, v202
    v_exp_f32 v203, v203
    v_exp_f32 v204, v204
    v_exp_f32 v205, v205
    s_waitcnt lgkmcnt(2)
    v_smfmac_f32_32x32x32_bf16 v[160:175], v[132:135], v[192:199], v14
    v_exp_f32 v206, v206
    v_exp_f32 v207, v207
    v_exp_f32 v208, v208
    v_exp_f32 v209, v209
    v_smfmac_f32_32x32x32_bf16 v[160:175], v[136:139], v[200:207], v14
    v_exp_f32 v210, v210
    v_exp_f32 v211, v211
    v_exp_f32 v212, v212
    v_exp_f32 v213, v213
    v_mfma_f32_32x32x16_bf16 v[224:239], v[148:151], v[8:11], v[224:239]
    v_add_u32 v16, 0xfffe3800, v16
    ds_read_b32 v156, v16 offset:0
    v_add_u32 v15, 0xfffe3800, v15
    ds_read_b64 v[148:149], v15 offset:0
    ds_read_b64 v[150:151], v15 offset:512
    v_exp_f32 v214, v214
    v_exp_f32 v215, v215
    v_exp_f32 v216, v216
    v_exp_f32 v217, v217
    s_waitcnt lgkmcnt(3)
    v_smfmac_f32_32x32x32_bf16 v[160:175], v[140:143], v[208:215], v14
    v_exp_f32 v218, v218
    v_exp_f32 v219, v219
    v_exp_f32 v220, v220
    v_exp_f32 v221, v221
    v_mfma_f32_32x32x16_bf16 v[240:255], v[152:155], v[8:11], v[240:255]
    ds_read_b64 v[152:153], v15 offset:256
    ds_read_b64 v[154:155], v15 offset:768
    v_exp_f32 v222, v222
    v_exp_f32 v223, v223
    v_exp_f32 v224, v224
    v_exp_f32 v225, v225
    v_smfmac_f32_32x32x32_bf16 v[160:175], v[144:147], v[216:223], v14
    v_exp_f32 v226, v226
    v_exp_f32 v227, v227
    v_exp_f32 v228, v228
    v_exp_f32 v229, v229
    s_waitcnt lgkmcnt(4)
    v_mfma_f32_32x32x4_2b_bf16 v[192:223], v[156:157], v[12:13], 0
    v_exp_f32 v230, v230
    v_exp_f32 v231, v231
    v_exp_f32 v232, v232
    v_exp_f32 v233, v233
    v_exp_f32 v234, v234
    v_exp_f32 v235, v235
    v_exp_f32 v236, v236
    v_exp_f32 v237, v237
    v_smfmac_f32_32x32x32_bf16 v[176:191], v[132:135], v[224:231], v14
    v_exp_f32 v238, v238
    v_exp_f32 v239, v239
    v_exp_f32 v240, v240
    v_exp_f32 v241, v241
    v_smfmac_f32_32x32x32_bf16 v[176:191], v[136:139], v[232:239], v14
    v_add_u32 v17, 0xfffe3800, v17
    s_mov_b64 exec, s[46:47]
    ds_read_b128 v[132:135], v17 offset:0
    ds_read_b128 v[136:139], v17 offset:576
    s_mov_b64 exec, -1
    s_waitcnt vmcnt(0)
    ds_read_b128 v[122:125], v27 offset:0
    ds_read_b128 v[114:117], v26 offset:0
    ds_read_b128 v[118:121], v26 offset:1024
    s_mov_b32 s65, 0
    s_mov_b32 s64, 0x37800000
L_meet_31:
    s_waitcnt lgkmcnt(0)
    v_cmp_ne_u32 vcc, s31, v125
    s_cbranch_vccnz L_meet_31_r
L_meet_31_k:
    v_add_f32 v170, v170, v124
    v_pk_add_f32 v[168:169], v[168:169], v[122:123]
    v_pk_add_f32 v[160:161], v[160:161], v[114:115]
    v_pk_add_f32 v[162:163], v[162:163], v[116:117]
    v_pk_add_f32 v[164:165], v[164:165], v[118:119]
    v_pk_add_f32 v[166:167], v[166:167], v[120:121]
L_norm_32:
    v_rcp_f32 v24, v170
    v_mov_b32 v125, 0x7b800000
    v_pk_mul_f32 v[114:115], v[160:161], v[24:25] op_sel_hi:[1,0]
    v_pk_mul_f32 v[116:117], v[162:163], v[24:25] op_sel_hi:[1,0]
    v_pk_mul_f32 v[118:119], v[164:165], v[24:25] op_sel_hi:[1,0]
    v_pk_mul_f32 v[120:121], v[166:167], v[24:25] op_sel_hi:[1,0]
    v_pk_mul_f32 v[122:123], v[168:169], v[24:25] op_sel_hi:[1,0]
    v_med3_f32 v124, v170, s64, v125
    v_pk_add_f32 v[24:25], v[114:115], v[116:117]
    v_pk_add_f32 v[24:25], v[24:25], v[118:119]
    v_pk_add_f32 v[24:25], v[24:25], v[120:121]
    v_pk_add_f32 v[24:25], v[24:25], v[122:123]
    v_add_f32 v24, v24, v25
    v_fma_f32 v24, v24, 0, v170
    v_cmp_neq_f32 vcc, v124, v24
    v_cvt_pk_bf16_f32 v114, v114, v115
    v_cvt_pk_bf16_f32 v115, v116, v117
    v_cvt_pk_bf16_f32 v116, v118, v119
    v_cvt_pk_bf16_f32 v117, v120, v121
    v_cvt_pk_bf16_f32 v118, v122, v123
    s_cbranch_vccnz L_slowp_34
L_normok_33:
    v_lshlrev_b32 v24, 2, v1
    buffer_store_dwordx4 v[114:117], v40, s[20:23], s34 offen sc1
    s_mov_b32 exec_hi, 0
    buffer_store_dword v118, v24, s[20:23], s3 offen sc1
    s_mov_b64 exec, -1
    v_subrev_u32 v26, 97280, v26
    s_mov_b64 exec, 1
    ds_write_b32 v158, v0 offset:256
    s_mov_b64 exec, -1
    v_exp_f32 v242, v242
    v_exp_f32 v243, v243
    v_exp_f32 v244, v244
    v_exp_f32 v245, v245
    v_mfma_f32_32x32x16_bf16 v[192:207], v[148:151], v[8:11], v[192:207]
    ds_read_b32 v156, v16 offset:9728
    ds_read_b64 v[148:149], v15 offset:9728
    ds_read_b64 v[150:151], v15 offset:10240
    v_exp_f32 v246, v246
    v_exp_f32 v247, v247
    v_exp_f32 v248, v248
    v_exp_f32 v249, v249
    v_smfmac_f32_32x32x32_bf16 v[176:191], v[140:143], v[240:247], v14
    v_exp_f32 v250, v250
    v_exp_f32 v251, v251
    v_exp_f32 v252, v252
    v_exp_f32 v253, v253
    v_mfma_f32_32x32x16_bf16 v[208:223], v[152:155], v[8:11], v[208:223]
    ds_read_b64 v[152:153], v15 offset:9984
    ds_read_b64 v[154:155], v15 offset:10496
    v_exp_f32 v254, v254
    v_exp_f32 v255, v255
    v_exp_f32 v192, v192
    v_exp_f32 v193, v193
    v_smfmac_f32_32x32x32_bf16 v[176:191], v[144:147], v[248:255], v14
    s_mov_b64 exec, s[46:47]
    ds_read_b128 v[140:143], v17 offset:1152
    ds_read_b128 v[144:147], v17 offset:1728
    s_mov_b64 exec, -1
    s_setprio 2
    v_exp_f32 v194, v194
    v_exp_f32 v195, v195
    v_exp_f32 v196, v196
    v_exp_f32 v197, v197
    s_waitcnt lgkmcnt(6)
    v_mfma_f32_32x32x4_2b_bf16 v[224:255], v[156:157], v[12:13], 0
    v_exp_f32 v198, v198
    v_exp_f32 v199, v199
    v_exp_f32 v200, v200
    v_exp_f32 v201, v201
    v_exp_f32 v202, v202
    v_exp_f32 v203, v203
    v_exp_f32 v204, v204
    v_exp_f32 v205, v205
    v_smfmac_f32_32x32x32_bf16 v[176:191], v[132:135], v[192:199], v14
    s_waitcnt vmcnt(0)
    s_mov_b64 exec, 1
    buffer_store_dword v0, off, s[20:23], s15 offset:0 sc1
    s_mov_b64 exec, -1
    v_exp_f32 v206, v206
    v_exp_f32 v207, v207
    v_exp_f32 v208, v208
    v_exp_f32 v209, v209
    v_smfmac_f32_32x32x32_bf16 v[176:191], v[136:139], v[200:207], v14
    s_mov_b64 exec, s[46:47]
    ds_read_b128 v[132:135], v17 offset:9728
    ds_read_b128 v[136:139], v17 offset:10304
    s_mov_b64 exec, -1
    v_exp_f32 v210, v210
    v_exp_f32 v211, v211
    v_exp_f32 v212, v212
    v_exp_f32 v213, v213
    s_waitcnt lgkmcnt(6)
    v_mfma_f32_32x32x16_bf16 v[224:239], v[148:151], v[8:11], v[224:239]
    ds_read_b32 v156, v16 offset:19456
    ds_read_b64 v[148:149], v15 offset:19456
    ds_read_b64 v[150:151], v15 offset:19968
    v_exp_f32 v214, v214
    v_exp_f32 v215, v215
    v_exp_f32 v216, v216
    v_exp_f32 v217, v217
    s_waitcnt lgkmcnt(5)
    v_smfmac_f32_32x32x32_bf16 v[176:191], v[140:143], v[208:215], v14
    v_exp_f32 v218, v218
    v_exp_f32 v219, v219
    v_exp_f32 v220, v220
    v_exp_f32 v221, v221
    v_mfma_f32_32x32x16_bf16 v[240:255], v[152:155], v[8:11], v[240:255]
    ds_read_b64 v[152:153], v15 offset:19712
    ds_read_b64 v[154:155], v15 offset:20224
    v_exp_f32 v222, v222
    v_exp_f32 v223, v223
    v_exp_f32 v224, v224
    v_exp_f32 v225, v225
    v_smfmac_f32_32x32x32_bf16 v[176:191], v[144:147], v[216:223], v14
    s_mov_b64 exec, s[46:47]
    ds_read_b128 v[140:143], v17 offset:10880
    ds_read_b128 v[144:147], v17 offset:11456
    s_mov_b64 exec, -1
    v_exp_f32 v226, v226
    v_exp_f32 v227, v227
    v_exp_f32 v228, v228
    v_exp_f32 v229, v229
    s_waitcnt lgkmcnt(6)
    v_mfma_f32_32x32x4_2b_bf16 v[192:223], v[156:157], v[12:13], 0
    v_exp_f32 v230, v230
    v_exp_f32 v231, v231
    v_exp_f32 v232, v232
    v_exp_f32 v233, v233
    v_exp_f32 v234, v234
    v_exp_f32 v235, v235
    v_exp_f32 v236, v236
    v_exp_f32 v237, v237
    v_smfmac_f32_32x32x32_bf16 v[176:191], v[132:135], v[224:231], v14
    v_exp_f32 v238, v238
    v_exp_f32 v239, v239
    v_exp_f32 v240, v240
    v_exp_f32 v241, v241
    v_smfmac_f32_32x32x32_bf16 v[176:191], v[136:139], v[232:239], v14
    s_mov_b64 exec, s[46:47]
    ds_read_b128 v[132:135], v17 offset:19456
    ds_read_b128 v[136:139], v17 offset:20032
    s_mov_b64 exec, -1
L_pad6:
    s_cbranch_execz L_warm_ret
    v_exp_f32 v242, v242
    v_exp_f32 v243, v243
    v_exp_f32 v244, v244
    v_exp_f32 v245, v245
    s_waitcnt lgkmcnt(6)
    v_mfma_f32_32x32x16_bf16 v[192:207], v[148:151], v[8:11], v[192:207]
    ds_read_b32 v156, v16 offset:29184
    ds_read_b64 v[148:149], v15 offset:29184
    ds_read_b64 v[150:151], v15 offset:29696
    v_exp_f32 v246, v246
    v_exp_f32 v247, v247
    v_exp_f32 v248, v248
    v_exp_f32 v249, v249
    s_waitcnt lgkmcnt(5)
    v_smfmac_f32_32x32x32_bf16 v[176:191], v[140:143], v[240:247], v14
    v_exp_f32 v250, v250
    v_exp_f32 v251, v251
    v_exp_f32 v252, v252
    v_exp_f32 v253, v253
    v_mfma_f32_32x32x16_bf16 v[208:223], v[152:155], v[8:11], v[208:223]
    ds_read_b64 v[152:153], v15 offset:29440
    ds_read_b64 v[154:155], v15 offset:29952
    v_exp_f32 v254, v254
    v_exp_f32 v255, v255
    v_exp_f32 v192, v192
    v_exp_f32 v193, v193
    v_smfmac_f32_32x32x32_bf16 v[176:191], v[144:147], v[248:255], v14
    s_mov_b64 exec, s[46:47]
    ds_read_b128 v[140:143], v17 offset:20608
    ds_read_b128 v[144:147], v17 offset:21184
    s_mov_b64 exec, -1
    v_exp_f32 v194, v194
    v_exp_f32 v195, v195
    v_exp_f32 v196, v196
    v_exp_f32 v197, v197
    s_waitcnt lgkmcnt(6)
    v_mfma_f32_32x32x4_2b_bf16 v[224:255], v[156:157], v[12:13], 0
    v_exp_f32 v198, v198
    v_exp_f32 v199, v199
    v_exp_f32 v200, v200
    v_exp_f32 v201, v201
    v_exp_f32 v202, v202
    v_exp_f32 v203, v203
    v_exp_f32 v204, v204
    v_exp_f32 v205, v205
    v_smfmac_f32_32x32x32_bf16 v[176:191], v[132:135], v[192:199], v14
    v_exp_f32 v206, v206
    v_exp_f32 v207, v207
    v_exp_f32 v208, v208
    v_exp_f32 v209, v209
    v_smfmac_f32_32x32x32_bf16 v[176:191], v[136:139], v[200:207], v14
    s_mov_b64 exec, s[46:47]
    ds_read_b128 v[132:135], v17 offset:29184
    ds_read_b128 v[136:139], v17 offset:29760
    s_mov_b64 exec, -1
    v_exp_f32 v210, v210
    v_exp_f32 v211, v211
    v_exp_f32 v212, v212
    v_exp_f32 v213, v213
    s_waitcnt lgkmcnt(6)
    v_mfma_f32_32x32x16_bf16 v[224:239], v[148:151], v[8:11], v[224:239]
    ds_read_b32 v156, v16 offset:38912
    ds_read_b64 v[148:149], v15 offset:38912
    ds_read_b64 v[150:151], v15 offset:39424
    v_exp_f32 v214, v214
    v_exp_f32 v215, v215
    v_exp_f32 v216, v216
    v_exp_f32 v217, v217
    s_waitcnt lgkmcnt(5)
    v_smfmac_f32_32x32x32_bf16 v[176:191], v[140:143], v[208:215], v14
    v_exp_f32 v218, v218
    v_exp_f32 v219, v219
    v_exp_f32 v220, v220
    v_exp_f32 v221, v221
    v_mfma_f32_32x32x16_bf16 v[240:255], v[152:155], v[8:11], v[240:255]
    ds_read_b64 v[152:153], v15 offset:39168
    ds_read_b64 v[154:155], v15 offset:39680
    v_exp_f32 v222, v222
    v_exp_f32 v223, v223
    v_exp_f32 v224, v224
    v_exp_f32 v225, v225
    v_smfmac_f32_32x32x32_bf16 v[176:191], v[144:147], v[216:223], v14
    s_mov_b64 exec, s[46:47]
    ds_read_b128 v[140:143], v17 offset:30336
    ds_read_b128 v[144:147], v17 offset:30912
    s_mov_b64 exec, -1
    v_exp_f32 v226, v226
    v_exp_f32 v227, v227
    v_exp_f32 v228, v228
    v_exp_f32 v229, v229
    s_waitcnt lgkmcnt(6)
    v_mfma_f32_32x32x4_2b_bf16 v[192:223], v[156:157], v[12:13], 0
    v_exp_f32 v230, v230
    v_exp_f32 v231, v231
    v_exp_f32 v232, v232
    v_exp_f32 v233, v233
    v_exp_f32 v234, v234
    v_exp_f32 v235, v235
    v_exp_f32 v236, v236
    v_exp_f32 v237, v237
    v_smfmac_f32_32x32x32_bf16 v[176:191], v[132:135], v[224:231], v14
    v_exp_f32 v238, v238
    v_exp_f32 v239, v239
    v_exp_f32 v240, v240
    v_exp_f32 v241, v241
    v_smfmac_f32_32x32x32_bf16 v[176:191], v[136:139], v[232:239], v14
    s_mov_b64 exec, s[46:47]
    ds_read_b128 v[132:135], v17 offset:38912
    ds_read_b128 v[136:139], v17 offset:39488
    s_mov_b64 exec, -1
    v_exp_f32 v242, v242
    v_exp_f32 v243, v243
    v_exp_f32 v244, v244
    v_exp_f32 v245, v245
    s_waitcnt lgkmcnt(6)
    v_mfma_f32_32x32x16_bf16 v[192:207], v[148:151], v[8:11], v[192:207]
    ds_read_b32 v156, v16 offset:48640
    ds_read_b64 v[148:149], v15 offset:48640
    ds_read_b64 v[150:151], v15 offset:49152
    v_exp_f32 v246, v246
    v_exp_f32 v247, v247
    v_exp_f32 v248, v248
    v_exp_f32 v249, v249
    s_waitcnt lgkmcnt(5)
    v_smfmac_f32_32x32x32_bf16 v[176:191], v[140:143], v[240:247], v14
    v_exp_f32 v250, v250
    v_exp_f32 v251, v251
    v_exp_f32 v252, v252
    v_exp_f32 v253, v253
    v_mfma_f32_32x32x16_bf16 v[208:223], v[152:155], v[8:11], v[208:223]
    ds_read_b64 v[152:153], v15 offset:48896
    ds_read_b64 v[154:155], v15 offset:49408
    v_exp_f32 v254, v254
    v_exp_f32 v255, v255
    v_exp_f32 v192, v192
    v_exp_f32 v193, v193
    v_smfmac_f32_32x32x32_bf16 v[176:191], v[144:147], v[248:255], v14
    s_mov_b64 exec, s[46:47]
    ds_read_b128 v[140:143], v17 offset:40064
    ds_read_b128 v[144:147], v17 offset:40640
    s_mov_b64 exec, -1
    v_exp_f32 v194, v194
    v_exp_f32 v195, v195
    v_exp_f32 v196, v196
    v_exp_f32 v197, v197
    s_waitcnt lgkmcnt(6)
    v_mfma_f32_32x32x4_2b_bf16 v[224:255], v[156:157], v[12:13], 0
    v_exp_f32 v198, v198
    v_exp_f32 v199, v199
    v_exp_f32 v200, v200
    v_exp_f32 v201, v201
    v_exp_f32 v202, v202
    v_exp_f32 v203, v203
    v_exp_f32 v204, v204
    v_exp_f32 v205, v205
    v_smfmac_f32_32x32x32_bf16 v[176:191], v[132:135], v[192:199], v14
    v_exp_f32 v206, v206
    v_exp_f32 v207, v207
    v_exp_f32 v208, v208
    v_exp_f32 v209, v209
    v_smfmac_f32_32x32x32_bf16 v[176:191], v[136:139], v[200:207], v14
    s_mov_b64 exec, s[46:47]
    ds_read_b128 v[132:135], v17 offset:48640
    ds_read_b128 v[136:139], v17 offset:49216
    s_mov_b64 exec, -1
    v_exp_f32 v210, v210
    v_exp_f32 v211, v211
    v_exp_f32 v212, v212
    v_exp_f32 v213, v213
    s_waitcnt lgkmcnt(6)
    v_mfma_f32_32x32x16_bf16 v[224:239], v[148:151], v[8:11], v[224:239]
    v_exp_f32 v214, v214
    v_exp_f32 v215, v215
    v_exp_f32 v216, v216
    v_exp_f32 v217, v217
    s_waitcnt lgkmcnt(2)
    v_smfmac_f32_32x32x32_bf16 v[176:191], v[140:143], v[208:215], v14
    s_setprio 1
    v_exp_f32 v218, v218
    v_exp_f32 v219, v219
    v_exp_f32 v220, v220
    v_exp_f32 v221, v221
    v_mfma_f32_32x32x16_bf16 v[240:255], v[152:155], v[8:11], v[240:255]
    v_exp_f32 v222, v222
    v_exp_f32 v223, v223
    v_exp_f32 v224, v224
    v_exp_f32 v225, v225
    v_smfmac_f32_32x32x32_bf16 v[176:191], v[144:147], v[216:223], v14
    s_mov_b64 exec, s[46:47]
    ds_read_b128 v[140:143], v17 offset:49792
    ds_read_b128 v[144:147], v17 offset:50368
    s_mov_b64 exec, -1
    v_exp_f32 v226, v226
    v_exp_f32 v227, v227
    v_exp_f32 v228, v228
    v_exp_f32 v229, v229
    v_exp_f32 v230, v230
    v_exp_f32 v231, v231
    v_exp_f32 v232, v232
    v_exp_f32 v233, v233
    v_exp_f32 v234, v234
    v_exp_f32 v235, v235
    v_exp_f32 v236, v236
    v_exp_f32 v237, v237
    s_waitcnt lgkmcnt(2)
    v_smfmac_f32_32x32x32_bf16 v[176:191], v[132:135], v[224:231], v14
    s_setprio 0
    v_exp_f32 v238, v238
    v_exp_f32 v239, v239
    v_exp_f32 v240, v240
    v_exp_f32 v241, v241
    v_smfmac_f32_32x32x32_bf16 v[176:191], v[136:139], v[232:239], v14
    v_exp_f32 v242, v242
    v_exp_f32 v243, v243
    v_exp_f32 v244, v244
    v_exp_f32 v245, v245
    v_exp_f32 v246, v246
    v_exp_f32 v247, v247
    v_exp_f32 v248, v248
    v_exp_f32 v249, v249
    s_waitcnt lgkmcnt(0)
    v_smfmac_f32_32x32x32_bf16 v[176:191], v[140:143], v[240:247], v14
    s_mov_b64 exec, 1
    buffer_store_dword v0, off, s[20:23], s15 offset:4 sc1
    s_mov_b64 exec, -1
    ds_read_b128 v[122:125], v27 offset:9728
    ds_read_b128 v[114:117], v26 offset:0
    ds_read_b128 v[118:121], v26 offset:1024
    v_exp_f32 v250, v250
    v_exp_f32 v251, v251
    v_exp_f32 v252, v252
    v_exp_f32 v253, v253
    v_exp_f32 v254, v254
    v_exp_f32 v255, v255
    s_nop 1
    v_smfmac_f32_32x32x32_bf16 v[176:191], v[144:147], v[248:255], v14
    v_subrev_u32 v159, 32, v159
    s_nop 5
    s_mov_b32 s65, 0
    s_mov_b32 s64, 0x37800000
L_meet_35:
    s_waitcnt lgkmcnt(0)
    v_cmp_ne_u32 vcc, s31, v125
    s_cbranch_vccnz L_meet_35_r
L_meet_35_k:
    v_add_f32 v186, v186, v124
    v_pk_add_f32 v[184:185], v[184:185], v[122:123]
    v_pk_add_f32 v[176:177], v[176:177], v[114:115]
    v_pk_add_f32 v[178:179], v[178:179], v[116:117]
    v_pk_add_f32 v[180:181], v[180:181], v[118:119]
    v_pk_add_f32 v[182:183], v[182:183], v[120:121]
L_norm_36:
    v_rcp_f32 v24, v186
    v_mov_b32 v125, 0x7b800000
    v_pk_mul_f32 v[114:115], v[176:177], v[24:25] op_sel_hi:[1,0]
    v_pk_mul_f32 v[116:117], v[178:179], v[24:25] op_sel_hi:[1,0]
    v_pk_mul_f32 v[118:119], v[180:181], v[24:25] op_sel_hi:[1,0]
    v_pk_mul_f32 v[120:121], v[182:183], v[24:25] op_sel_hi:[1,0]
    v_pk_mul_f32 v[122:123], v[184:185], v[24:25] op_sel_hi:[1,0]
    v_med3_f32 v124, v186, s64, v125
    v_pk_add_f32 v[24:25], v[114:115], v[116:117]
    v_pk_add_f32 v[24:25], v[24:25], v[118:119]
    v_pk_add_f32 v[24:25], v[24:25], v[120:121]
    v_pk_add_f32 v[24:25], v[24:25], v[122:123]
    v_add_f32 v24, v24, v25
    v_fma_f32 v24, v24, 0, v186
    v_cmp_neq_f32 vcc, v124, v24
    v_cvt_pk_bf16_f32 v114, v114, v115
    v_cvt_pk_bf16_f32 v115, v116, v117
    v_cvt_pk_bf16_f32 v116, v118, v119
    v_cvt_pk_bf16_f32 v117, v120, v121
    v_cvt_pk_bf16_f32 v118, v122, v123
    s_cbranch_vccnz L_slowp_38
L_normok_37:
    v_lshlrev_b32 v24, 2, v1
    s_add_u32 s61, s34, 1183744
    s_add_u32 s62, s3, 1183744
    buffer_store_dwordx4 v[114:117], v40, s[20:23], s61 offen sc1
    s_mov_b32 exec_hi, 0
    buffer_store_dword v118, v24, s[20:23], s62 offen sc1
    s_mov_b64 exec, -1
    s_mov_b64 exec, 1
    ds_write_b32 v158, v0 offset:448
    s_mov_b64 exec, -1
    ds_read_b32 v24, v159 offset:384
    s_waitcnt lgkmcnt(0)
L_word_39:
    v_cmp_ne_u32 vcc, s31, v24
    s_cbranch_vccnz L_word_39_r
L_word_39_k:
    s_cmp_eq_u32 s54, 0
    s_cbranch_scc1 L_ysh
    ds_read_b128 v[192:195], v32 offset:39936
    ds_read_b128 v[196:199], v32 offset:44288
    ds_read_b128 v[200:203], v32 offset:48640
    ds_read_b128 v[204:207], v32 offset:52992
    ds_read_b128 v[208:211], v32 offset:22528
    ds_read_b128 v[212:215], v32 offset:26880
    ds_read_b128 v[216:219], v32 offset:31232
    ds_read_b128 v[220:223], v32 offset:35584
    s_waitcnt lgkmcnt(6)
    v_add_f32 v192, v192, v196
    v_add_f32 v193, v193, v197
    v_add_f32 v194, v194, v198
    v_add_f32 v195, v195, v199
    s_waitcnt lgkmcnt(5)
    v_add_f32 v192, v192, v200
    v_add_f32 v193, v193, v201
    v_add_f32 v194, v194, v202
    v_add_f32 v195, v195, v203
    s_waitcnt lgkmcnt(4)
    v_add_f32 v192, v192, v204
    v_add_f32 v193, v193, v205
    v_add_f32 v194, v194, v206
    v_add_f32 v195, v195, v207
    v_cvt_pk_bf16_f32 v192, v192, v193
    v_cvt_pk_bf16_f32 v193, v194, v195
    buffer_store_dwordx2 v[192:193], v34, s[16:19], s76 offen
    s_waitcnt lgkmcnt(2)
    v_add_f32 v208, v208, v212
    v_add_f32 v209, v209, v213
    v_add_f32 v210, v210, v214
    v_add_f32 v211, v211, v215
    s_waitcnt lgkmcnt(1)
    v_add_f32 v208, v208, v216
    v_add_f32 v209, v209, v217
    v_add_f32 v210, v210, v218
    v_add_f32 v211, v211, v219
    s_waitcnt lgkmcnt(0)
    v_add_f32 v208, v208, v220
    v_add_f32 v209, v209, v221
    v_add_f32 v210, v210, v222
    v_add_f32 v211, v211, v223
    v_cvt_pk_bf16_f32 v208, v208, v209
    v_cvt_pk_bf16_f32 v209, v210, v211
    buffer_store_dwordx2 v[208:209], v34, s[16:19], s75 offen
    s_add_u32 s76, s76, 1179648
    s_add_u32 s77, s77, 1179648
    s_setprio 0
    s_barrier
    ds_read_b128 v[44:47], v32 offset:0
    ds_read_b128 v[48:51], v32 offset:4352
    ds_read_b128 v[52:55], v32 offset:8704
    ds_read_b128 v[56:59], v32 offset:13056
    s_waitcnt lgkmcnt(2)
    v_pk_add_f32 v[44:45], v[44:45], v[48:49]
    v_pk_add_f32 v[46:47], v[46:47], v[50:51]
    s_waitcnt lgkmcnt(1)
    v_pk_add_f32 v[44:45], v[44:45], v[52:53]
    v_pk_add_f32 v[46:47], v[46:47], v[54:55]
    s_waitcnt lgkmcnt(0)
    v_pk_add_f32 v[44:45], v[44:45], v[56:57]
    v_pk_add_f32 v[46:47], v[46:47], v[58:59]
    v_cvt_pk_bf16_f32 v44, v44, v45
    v_cvt_pk_bf16_f32 v45, v46, v47
    buffer_store_dwordx2 v[44:45], v34, s[16:19], s76 offen
    s_endpgm
L_ysh:
    ds_read_b128 v[192:195], v32 offset:39936
    ds_read_b128 v[196:199], v32 offset:44288
    ds_read_b128 v[200:203], v32 offset:48640
    ds_read_b128 v[204:207], v32 offset:52992
    ds_read_b128 v[208:211], v32 offset:22528
    ds_read_b128 v[212:215], v32 offset:26880
    ds_read_b128 v[216:219], v32 offset:31232
    ds_read_b128 v[220:223], v32 offset:35584
    ds_read_b128 v[224:227], v33 offset:39936
    ds_read_b128 v[228:231], v33 offset:41216
    ds_read_b128 v[232:235], v33 offset:42496
    ds_read_b128 v[236:239], v33 offset:43776
    s_waitcnt lgkmcnt(10)
    v_add_f32 v192, v192, v196
    v_add_f32 v193, v193, v197
    v_add_f32 v194, v194, v198
    v_add_f32 v195, v195, v199
    s_waitcnt lgkmcnt(9)
    v_add_f32 v192, v192, v200
    v_add_f32 v193, v193, v201
    v_add_f32 v194, v194, v202
    v_add_f32 v195, v195, v203
    s_waitcnt lgkmcnt(8)
    v_add_f32 v192, v192, v204
    v_add_f32 v193, v193, v205
    v_add_f32 v194, v194, v206
    v_add_f32 v195, v195, v207
    v_cvt_pk_bf16_f32 v192, v192, v193
L_pad7:
    s_cbranch_execz L_warm_ret
    v_cvt_pk_bf16_f32 v193, v194, v195
    buffer_store_dwordx2 v[192:193], v34, s[16:19], s76 offen
    s_waitcnt lgkmcnt(6)
    v_add_f32 v208, v208, v212
    v_add_f32 v209, v209, v213
    v_add_f32 v210, v210, v214
    v_add_f32 v211, v211, v215
    s_waitcnt lgkmcnt(5)
    v_add_f32 v208, v208, v216
    v_add_f32 v209, v209, v217
    v_add_f32 v210, v210, v218
    v_add_f32 v211, v211, v219
    s_waitcnt lgkmcnt(4)
    v_add_f32 v208, v208, v220
    v_add_f32 v209, v209, v221
    v_add_f32 v210, v210, v222
    v_add_f32 v211, v211, v223
    v_cvt_pk_bf16_f32 v208, v208, v209
    v_cvt_pk_bf16_f32 v209, v210, v211
    buffer_store_dwordx2 v[208:209], v34, s[16:19], s75 offen
    s_waitcnt lgkmcnt(2)
    v_add_f32 v224, v224, v228
    v_add_f32 v225, v225, v229
    v_add_f32 v226, v226, v230
    v_add_f32 v227, v227, v231
    s_waitcnt lgkmcnt(1)
    v_add_f32 v224, v224, v232
    v_add_f32 v225, v225, v233
    v_add_f32 v226, v226, v234
    v_add_f32 v227, v227, v235
    s_waitcnt lgkmcnt(0)
    v_add_f32 v224, v224, v236
    v_add_f32 v225, v225, v237
    v_add_f32 v226, v226, v238
    v_add_f32 v227, v227, v239
    v_cvt_pk_bf16_f32 v224, v224, v225
    v_cvt_pk_bf16_f32 v225, v226, v227
    buffer_store_dwordx2 v[224:225], v35, s[16:19], s77 offen
    s_add_u32 s76, s76, 1179648
    s_add_u32 s77, s77, 1179648
    s_setprio 1
    s_barrier
    ds_read_b128 v[44:47], v32 offset:0
    ds_read_b128 v[48:51], v32 offset:4352
    ds_read_b128 v[52:55], v32 offset:8704
    ds_read_b128 v[56:59], v32 offset:13056
    ds_read_b128 v[76:79], v33 offset:0
    ds_read_b128 v[80:83], v33 offset:1280
    ds_read_b128 v[84:87], v33 offset:2560
    ds_read_b128 v[88:91], v33 offset:3840
    s_waitcnt lgkmcnt(6)
    v_pk_add_f32 v[44:45], v[44:45], v[48:49]
    v_pk_add_f32 v[46:47], v[46:47], v[50:51]
    s_waitcnt lgkmcnt(5)
    v_pk_add_f32 v[44:45], v[44:45], v[52:53]
    v_pk_add_f32 v[46:47], v[46:47], v[54:55]
    s_waitcnt lgkmcnt(4)
    v_pk_add_f32 v[44:45], v[44:45], v[56:57]
    v_pk_add_f32 v[46:47], v[46:47], v[58:59]
    v_cvt_pk_bf16_f32 v44, v44, v45
    v_cvt_pk_bf16_f32 v45, v46, v47
    buffer_store_dwordx2 v[44:45], v34, s[16:19], s76 offen
    s_waitcnt lgkmcnt(2)
    v_pk_add_f32 v[76:77], v[76:77], v[80:81]
    v_pk_add_f32 v[78:79], v[78:79], v[82:83]
    s_waitcnt lgkmcnt(1)
    v_pk_add_f32 v[76:77], v[76:77], v[84:85]
    v_pk_add_f32 v[78:79], v[78:79], v[86:87]
    s_waitcnt lgkmcnt(0)
    v_pk_add_f32 v[76:77], v[76:77], v[88:89]
    v_pk_add_f32 v[78:79], v[78:79], v[90:91]
    v_cvt_pk_bf16_f32 v76, v76, v77
    v_cvt_pk_bf16_f32 v77, v78, v79
    buffer_store_dwordx2 v[76:77], v35, s[16:19], s77 offen
    s_endpgm
L_word_26_r:
    s_add_u32 s68, s68, 1
    s_cmp_gt_u32 s68, 0x80000
    s_cbranch_scc1 L_word_26_k
    s_sleep 1
    ds_read_b32 v24, v159 offset:0
    s_waitcnt lgkmcnt(0)
    s_branch L_word_26
L_word_27_r:
    s_add_u32 s68, s68, 1
    s_cmp_gt_u32 s68, 0x80000
    s_cbranch_scc1 L_word_27_k
    s_sleep 1
    ds_read_b32 v24, v159 offset:64
    s_waitcnt lgkmcnt(0)
    s_branch L_word_27
L_poll_28_r:
    s_add_u32 s68, s68, 1
    s_cmp_gt_u32 s68, 0x80000
    s_cbranch_scc1 L_poll_28_k
    s_sleep 2
    buffer_load_dword v39, v38, s[20:23], 0 offen offset:4 sc1
    s_waitcnt vmcnt(0)
    s_branch L_poll_28
L_word_29_r:
    s_add_u32 s68, s68, 1
    s_cmp_gt_u32 s68, 0x80000
    s_cbranch_scc1 L_word_29_k
    s_sleep 1
    ds_read_b32 v24, v159 offset:128
    s_waitcnt lgkmcnt(0)
    s_branch L_word_29
L_word_30_r:
    s_add_u32 s68, s68, 1
    s_cmp_gt_u32 s68, 0x80000
    s_cbranch_scc1 L_word_30_k
    s_sleep 1
    ds_read_b32 v24, v159 offset:192
    s_waitcnt lgkmcnt(0)
    s_branch L_word_30
L_meet_31_r:
    s_add_u32 s68, s68, 1
    s_cmp_gt_u32 s68, 0x80000
    s_cbranch_scc1 L_meet_31_k
    s_sleep 1
    ds_read_b128 v[122:125], v27 offset:0
    ds_read_b128 v[114:117], v26 offset:0
    ds_read_b128 v[118:121], v26 offset:1024
    s_branch L_meet_31
L_meet_35_r:
    s_add_u32 s68, s68, 1
    s_cmp_gt_u32 s68, 0x80000
    s_cbranch_scc1 L_meet_35_k
    s_sleep 1
    ds_read_b128 v[122:125], v27 offset:9728
    ds_read_b128 v[114:117], v26 offset:0
    ds_read_b128 v[118:121], v26 offset:1024
    s_branch L_meet_35
L_word_39_r:
    s_add_u32 s68, s68, 1
    s_cmp_gt_u32 s68, 0x80000
    s_cbranch_scc1 L_word_39_k
    s_sleep 1
    ds_read_b32 v24, v159 offset:384
    s_waitcnt lgkmcnt(0)
    s_branch L_word_39
L_end1:
L_tag_2_r:
    s_add_u32 s68, s68, 1
    s_cmp_gt_u32 s68, 0x80000
    s_cbranch_scc1 L_tag_2_k
    s_sleep 4
    buffer_load_dword v0, off, s[24:27], 0 sc1
    s_waitcnt vmcnt(0)
    s_branch L_tag_2
L_tag_6_r:
    s_add_u32 s68, s68, 1
    s_cmp_gt_u32 s68, 0x80000
    s_cbranch_scc1 L_tag_6_k
    s_sleep 4
    buffer_load_dword v0, off, s[24:27], 0 sc1
    s_waitcnt vmcnt(0)
    s_branch L_tag_6
L_idle2:
    buffer_load_dword v0, off, s[24:27], 0 sc1
    s_and_b32 s60, s41, 1
    s_mul_i32 s60, s60, 4294965244
    s_add_u32 s60, s60, 2052
    s_lshl3_add_u32 s61, s28, s60
    v_mov_b32 v158, s61
    s_lshl_b32 s61, s43, 5
    s_add_u32 s61, s61, s60
    v_and_b32 v159, 3, v1
    v_lshl_add_u32 v159, v159, 3, s61
    s_mov_b32 s80, 0x440000
    s_mov_b32 s81, 0x440000
    v_mov_b32 v134, 0x3f803f80
    v_cndmask_b32 v132, 0, v134, s[80:81]
    v_mov_b32 v133, v132
    v_mov_b64 v[134:135], v[132:133]
    v_mov_b64 v[136:137], v[132:133]
    v_mov_b64 v[138:139], v[132:133]
    v_mov_b64 v[140:141], v[132:133]
    v_mov_b64 v[142:143], v[132:133]
    v_mov_b64 v[144:145], v[132:133]
    v_mov_b64 v[146:147], v[132:133]
    v_mov_b32 v157, 0x3f80
    v_mov_b64 v[160:161], 0
    v_mov_b64 v[162:163], 0
    v_mov_b64 v[164:165], 0
    v_mov_b64 v[166:167], 0
    v_mov_b64 v[168:169], 0
    v_mov_b64 v[170:171], 0
    v_mov_b64 v[172:173], 0
    v_mov_b64 v[174:175], 0
    v_mov_b64 v[176:177], 0
    v_mov_b64 v[178:179], 0
    v_mov_b64 v[180:181], 0
    v_mov_b64 v[182:183], 0
    v_mov_b64 v[184:185], 0
    v_mov_b64 v[186:187], 0
    v_mov_b64 v[188:189], 0
    v_mov_b64 v[190:191], 0
    s_sub_u32 s32, s2, 224
    s_cmp_ge_u32 s32, 18
    s_cbranch_scc1 L_nowo
    s_lshl_b32 s60, s28, 3
    v_lshrrev_b32 v42, 3, v1
    v_add_u32 v42, s60, v42
    v_mul_u32_u24 v42, 1152, v42
    v_and_b32 v43, 7, v1
    v_lshl_add_u32 v42, v43, 4, v42
    s_lshr_b32 s64, s32, 1
    s_lshl_b32 s61, s64, 7
    s_and_b32 s65, s32, 1
    s_mul_i32 s62, s65, 331776
    s_add_u32 s61, s61, s62
    s_lshl_b32 s62, s28, 10
    s_add_u32 m0, s62, 0
    s_nop 0
    buffer_load_dwordx4 v42, s[8:11], s61 offen lds
    s_add_u32 s61, s61, 73728
    s_add_u32 m0, s62, 8192
    s_nop 0
    buffer_load_dwordx4 v42, s[8:11], s61 offen lds
    s_add_u32 s61, s61, 73728
    s_add_u32 m0, s62, 16384
    s_nop 0
    buffer_load_dwordx4 v42, s[8:11], s61 offen lds
    s_add_u32 s61, s61, 73728
    s_add_u32 m0, s62, 24576
    s_nop 0
    buffer_load_dwordx4 v42, s[8:11], s61 offen lds
    s_add_u32 s61, s61, 73728
    s_add_u32 m0, s62, 32768
    s_cmp_ge_u32 s28, 4
    s_cselect_b32 s61, 0x40000000, s61
    buffer_load_dwordx4 v42, s[8:11], s61 offen lds
    s_and_b32 s60, s28, 3
    s_lshr_b32 s61, s28, 2
    s_mul_i32 s63, s61, 144
    s_lshl_b32 s62, s60, 5
    v_lshrrev_b32 v42, 5, v1
    v_mul_u32_u24 v42, 18, v42
    v_bfe_u32 v43, v1, 2, 3
    v_add3_u32 v42, v42, v43, s63
    v_and_b32 v44, 3, v1
    v_lshl_add_u32 v44, v44, 3, s62
    v_lshl_add_u32 v42, v42, 7, v44
    v_lshrrev_b32 v43, 3, v1
    v_mul_u32_u24 v43, 18, v43
    v_bfe_u32 v45, v1, 2, 1
    s_add_u32 s63, s63, 16
    v_add3_u32 v43, v43, v45, s63
    v_lshl_add_u32 v43, v43, 7, v44
    s_lshl2_add_u32 s62, s64, s60
    s_lshl1_add_u32 s62, s62, s65
    s_lshl1_add_u32 s62, s62, s61
    s_mul_i32 s62, s62, 4608
    s_add_u32 s62, s62, 9449472
    s_add_u32 s64, s62, 4096
    v_lshlrev_b32 v44, 4, v1
    v_lshlrev_b32 v45, 3, v1
    s_waitcnt vmcnt(0)
    s_barrier
    ds_read_b64_tr_b16 v[48:49], v42 offset:0
    ds_read_b64_tr_b16 v[50:51], v42 offset:1024
    ds_read_b64_tr_b16 v[52:53], v42 offset:4608
    ds_read_b64_tr_b16 v[54:55], v42 offset:5632
    ds_read_b64_tr_b16 v[56:57], v42 offset:9216
    ds_read_b64_tr_b16 v[58:59], v42 offset:10240
    ds_read_b64_tr_b16 v[60:61], v42 offset:13824
    ds_read_b64_tr_b16 v[62:63], v42 offset:14848
    ds_read_b64_tr_b16 v[64:65], v43
    s_waitcnt lgkmcnt(0)
    buffer_store_dwordx4 v[48:51], v44, s[20:23], s62 offen offset:0 sc1
    buffer_store_dwordx4 v[52:55], v44, s[20:23], s62 offen offset:1024 sc1
    buffer_store_dwordx4 v[56:59], v44, s[20:23], s62 offen offset:2048 sc1
    buffer_store_dwordx4 v[60:63], v44, s[20:23], s62 offen offset:3072 sc1
    buffer_store_dwordx2 v[64:65], v45, s[20:23], s64 offen sc1
    s_lshl_b32 s60, s32, 2
    s_add_u32 s60, s60, 10170364
    s_cmp_eq_u32 s28, 0
    s_cselect_b32 s58, s60, s58
L_nowo:
    s_branch L_warm
L_warm_idle:
    s_waitcnt vmcnt(0)
L_tag_40:
    v_readfirstlane_b32 s31, v0
    s_cmp_eq_u32 s31, 0
    s_cbranch_scc1 L_tag_40_r
L_tag_40_k:
    s_mov_b64 exec, 0x100
    buffer_load_dword v39, v38, s[20:23], 0 offen offset:0 sc1
    s_waitcnt vmcnt(0)
L_poll_41:
    v_cmp_ne_u32 vcc, s31, v39
    s_cbranch_vccnz L_poll_41_r
L_poll_41_k:
    s_mov_b64 exec, -1
    buffer_load_dword v39, v38, s[20:23], 0 offen offset:0 sc1
    s_waitcnt vmcnt(0)
L_poll_42:
    v_cmp_ne_u32 vcc, s31, v39
    s_cbranch_vccnz L_poll_42_r
L_poll_42_k:
    s_barrier
    s_cmp_eq_u32 s44, 3
    s_cbranch_scc1 L_fl_43
    s_add_u32 m0, s45, 0
    s_nop 0
    buffer_load_dwordx4 v18, s[20:23], s50 offen offset:0 sc1 lds
    buffer_load_dwordx4 v18, s[20:23], s50 offen offset:1024 sc1 lds
    buffer_load_dwordx4 v19, s[20:23], s50 offen offset:2048 sc1 lds
    s_cmp_ge_u32 s44, 2
    s_cbranch_scc1 L_fl_43_e
    buffer_load_dwordx4 v20, s[20:23], s50 offen offset:3072 sc1 lds
    s_add_u32 m0, m0, 4096
    s_mov_b64 exec, s[48:49]
    buffer_load_dwordx4 v21, s[20:23], s50 offen sc1 lds
    s_mov_b64 exec, -1
    s_branch L_fl_43_e
L_fl_43:
    s_lshl1_add_u32 s61, s42, s43
    s_mul_i32 s61, s61, 221312
    s_mul_i32 s60, s43, 2560
    s_add_u32 m0, s60, 155648
    v_subrev_u32 v24, 73728, v18
    buffer_load_dwordx4 v24, s[20:23], s61 offen offset:0 sc1 lds
    buffer_load_dwordx4 v24, s[20:23], s61 offen offset:1024 sc1 lds
    s_mov_b32 exec_hi, 0
    buffer_load_dwordx4 v24, s[20:23], s61 offen offset:2048 sc1 lds
    s_mov_b64 exec, -1
L_fl_43_e:
    s_barrier
    s_cmp_lg_u32 s44, 3
    s_cbranch_scc1 L_fl_44
    s_add_u32 m0, s45, 0
    s_nop 0
    buffer_load_dwordx4 v18, s[20:23], s50 offen offset:0 sc1 lds
    buffer_load_dwordx4 v18, s[20:23], s50 offen offset:1024 sc1 lds
    buffer_load_dwordx4 v19, s[20:23], s50 offen offset:2048 sc1 lds
L_fl_44:
    s_cmp_lt_u32 s44, 2
    s_cbranch_scc1 L_fl_44_e
    buffer_load_dwordx4 v20, s[20:23], s50 offen offset:3072 sc1 lds
    s_add_u32 m0, m0, 4096
    s_mov_b64 exec, s[48:49]
    buffer_load_dwordx4 v21, s[20:23], s50 offen sc1 lds
    s_mov_b64 exec, -1
L_fl_44_e:
    s_mov_b32 s40, 0x40000000
    s_mov_b32 s39, 0x40000000
    v_mov_b32 v46, 0
    s_branch L_attn
L_tag_40_r:
    s_add_u32 s68, s68, 1
    s_cmp_gt_u32 s68, 0x80000
    s_cbranch_scc1 L_tag_40_k
    s_sleep 4
    buffer_load_dword v0, off, s[24:27], 0 sc1
    s_waitcnt vmcnt(0)
    s_branch L_tag_40
L_poll_41_r:
    s_add_u32 s68, s68, 1
    s_cmp_gt_u32 s68, 0x80000
    s_cbranch_scc1 L_poll_41_k
    s_sleep 2
    buffer_load_dword v39, v38, s[20:23], 0 offen offset:0 sc1
    s_waitcnt vmcnt(0)
    s_branch L_poll_41
L_poll_42_r:
    s_add_u32 s68, s68, 1
    s_cmp_gt_u32 s68, 0x80000
    s_cbranch_scc1 L_poll_42_k
    buffer_load_dword v39, v38, s[20:23], 0 offen offset:0 sc1
    s_waitcnt vmcnt(0)
    s_branch L_poll_42
L_pfend:
L_slowp_34:
    s_cmp_eq_u32 s65, 0
    s_cbranch_scc1 L_slowp_34_go
    v_min_u32 v114, -2, v114
    v_min_u32 v115, -2, v115
    v_min_u32 v116, -2, v116
    v_min_u32 v117, -2, v117
    v_min_u32 v118, -2, v118
    v_min_u32 v119, -2, v119
    v_min_u32 v120, -2, v120
    v_min_u32 v121, -2, v121
    v_min_u32 v122, -2, v122
    v_min_u32 v123, -2, v123
    v_min_u32 v124, -2, v124
    v_min_u32 v125, -2, v125
    s_branch L_normok_33
L_slowp_34_go:
    s_mov_b32 s65, 1
    s_waitcnt vmcnt(0) lgkmcnt(0)
    s_mov_b32 s80, 0x440000
    s_mov_b32 s81, 0x440000
    v_mov_b32 v104, 0x3f803f80
    v_cndmask_b32 v88, 0, v104, s[80:81]
    v_mov_b32 v89, v88
    v_mov_b64 v[90:91], v[88:89]
    v_mov_b64 v[92:93], v[88:89]
    v_mov_b64 v[94:95], v[88:89]
    v_mov_b64 v[96:97], v[88:89]
    v_mov_b64 v[98:99], v[88:89]
    v_mov_b64 v[100:101], v[88:89]
    v_mov_b64 v[102:103], v[88:89]
    v_mov_b32 v85, 0
    v_mov_b32 v160, 0
    v_mov_b32 v161, 0
    v_mov_b32 v162, 0
    v_mov_b32 v163, 0
    v_mov_b32 v164, 0
    v_mov_b32 v165, 0
    v_mov_b32 v166, 0
    v_mov_b32 v167, 0
    v_mov_b32 v168, 0
    v_mov_b32 v169, 0
    v_mov_b32 v170, 0
    v_mov_b32 v171, 0
    v_mov_b32 v172, 0
    v_mov_b32 v173, 0
    v_mov_b32 v174, 0
    v_mov_b32 v175, 0
    v_lshrrev_b32 v104, 5, v1
    v_lshl_add_u32 v105, v104, 8, v23
    v_mul_u32_u24 v106, 9216, v104
    v_and_b32 v104, 31, v1
    v_lshl_add_u32 v106, v104, 4, v106
    s_mul_i32 s63, s41, 288
    s_add_u32 s63, s63, 73728
    v_add_u32 v106, s63, v106
    v_add_u32 v107, 18432, v106
    v_add_u32 v108, 18432, v107
    v_add_u32 v109, 18432, v108
    v_mov_b32 v104, 0xff800000
    s_mov_b32 s79, 73728
L_slow_45:
    buffer_load_dwordx2 v[76:77], v22, s[20:23], s79 offen offset:0 sc1
    buffer_load_dwordx2 v[78:79], v22, s[20:23], s79 offen offset:512 sc1
    buffer_load_dwordx2 v[80:81], v22, s[20:23], s79 offen offset:256 sc1
    buffer_load_dwordx2 v[82:83], v22, s[20:23], s79 offen offset:768 sc1
    buffer_load_dword v84, v105, s[20:23], s79 offen sc1
    s_waitcnt vmcnt(0)
    v_mfma_f32_32x32x4_2b_bf16 v[44:75], v[84:85], v[6:7], 0
    s_nop 15
    s_nop 1
    v_mfma_f32_32x32x16_bf16 v[44:59], v[76:79], v[2:5], v[44:59]
    v_mfma_f32_32x32x16_bf16 v[60:75], v[80:83], v[2:5], v[60:75]
    s_nop 11
    v_max3_f32 v104, v104, v44, v45
    v_max3_f32 v104, v104, v46, v47
    v_max3_f32 v104, v104, v48, v49
    v_max3_f32 v104, v104, v50, v51
    v_max3_f32 v104, v104, v52, v53
    v_max3_f32 v104, v104, v54, v55
    v_max3_f32 v104, v104, v56, v57
    v_max3_f32 v104, v104, v58, v59
    v_max3_f32 v104, v104, v60, v61
    v_max3_f32 v104, v104, v62, v63
    v_max3_f32 v104, v104, v64, v65
    v_max3_f32 v104, v104, v66, v67
    v_max3_f32 v104, v104, v68, v69
    v_max3_f32 v104, v104, v70, v71
    v_max3_f32 v104, v104, v72, v73
    v_max3_f32 v104, v104, v74, v75
    s_add_u32 s79, s79, 221312
    s_cmp_lt_u32 s79, 7081984
    s_cbranch_scc1 L_slow_45
    v_mov_b32 v44, v104
    s_nop 1
    v_permlane32_swap_b32 v44, v104
    s_nop 1
    v_max_f32 v104, v104, v44
    s_mov_b32 s79, 73728
L_slow_46:
    buffer_load_dwordx2 v[76:77], v22, s[20:23], s79 offen offset:0 sc1
    buffer_load_dwordx2 v[78:79], v22, s[20:23], s79 offen offset:512 sc1
    buffer_load_dwordx2 v[80:81], v22, s[20:23], s79 offen offset:256 sc1
    buffer_load_dwordx2 v[82:83], v22, s[20:23], s79 offen offset:768 sc1
    buffer_load_dword v84, v105, s[20:23], s79 offen sc1
    s_mov_b64 exec, s[46:47]
    buffer_load_dwordx4 v[88:91], v106, s[20:23], s79 offen sc1
    buffer_load_dwordx4 v[92:95], v107, s[20:23], s79 offen sc1
    buffer_load_dwordx4 v[96:99], v108, s[20:23], s79 offen sc1
    buffer_load_dwordx4 v[100:103], v109, s[20:23], s79 offen sc1
    s_mov_b64 exec, -1
    s_waitcnt vmcnt(0)
    v_mfma_f32_32x32x4_2b_bf16 v[44:75], v[84:85], v[6:7], 0
    s_nop 15
    s_nop 1
    v_mfma_f32_32x32x16_bf16 v[44:59], v[76:79], v[2:5], v[44:59]
    v_mfma_f32_32x32x16_bf16 v[60:75], v[80:83], v[2:5], v[60:75]
    s_nop 11
    v_sub_f32 v44, v44, v104
    v_sub_f32 v45, v45, v104
    v_sub_f32 v46, v46, v104
    v_sub_f32 v47, v47, v104
    v_sub_f32 v48, v48, v104
    v_sub_f32 v49, v49, v104
    v_sub_f32 v50, v50, v104
    v_sub_f32 v51, v51, v104
    v_sub_f32 v52, v52, v104
    v_sub_f32 v53, v53, v104
    v_sub_f32 v54, v54, v104
    v_sub_f32 v55, v55, v104
    v_sub_f32 v56, v56, v104
    v_sub_f32 v57, v57, v104
    v_sub_f32 v58, v58, v104
    v_sub_f32 v59, v59, v104
    v_sub_f32 v60, v60, v104
    v_sub_f32 v61, v61, v104
    v_sub_f32 v62, v62, v104
    v_sub_f32 v63, v63, v104
    v_sub_f32 v64, v64, v104
    v_sub_f32 v65, v65, v104
    v_sub_f32 v66, v66, v104
    v_sub_f32 v67, v67, v104
    v_sub_f32 v68, v68, v104
    v_sub_f32 v69, v69, v104
    v_sub_f32 v70, v70, v104
    v_sub_f32 v71, v71, v104
    v_sub_f32 v72, v72, v104
    v_sub_f32 v73, v73, v104
    v_sub_f32 v74, v74, v104
    v_sub_f32 v75, v75, v104
    v_exp_f32 v44, v44
    v_exp_f32 v45, v45
    v_exp_f32 v46, v46
    v_exp_f32 v47, v47
    v_exp_f32 v48, v48
    v_exp_f32 v49, v49
    v_exp_f32 v50, v50
    v_exp_f32 v51, v51
    v_exp_f32 v52, v52
    v_exp_f32 v53, v53
    v_exp_f32 v54, v54
    v_exp_f32 v55, v55
    v_exp_f32 v56, v56
    v_exp_f32 v57, v57
    v_exp_f32 v58, v58
    v_exp_f32 v59, v59
    v_exp_f32 v60, v60
    v_exp_f32 v61, v61
    v_exp_f32 v62, v62
    v_exp_f32 v63, v63
    v_exp_f32 v64, v64
    v_exp_f32 v65, v65
    v_exp_f32 v66, v66
    v_exp_f32 v67, v67
    v_exp_f32 v68, v68
    v_exp_f32 v69, v69
    v_exp_f32 v70, v70
    v_exp_f32 v71, v71
    v_exp_f32 v72, v72
    v_exp_f32 v73, v73
    v_exp_f32 v74, v74
    v_exp_f32 v75, v75
    s_nop 1
    v_smfmac_f32_32x32x32_bf16 v[160:175], v[88:91], v[44:51], v14
    v_smfmac_f32_32x32x32_bf16 v[160:175], v[92:95], v[52:59], v14
    v_smfmac_f32_32x32x32_bf16 v[160:175], v[96:99], v[60:67], v14
    v_smfmac_f32_32x32x32_bf16 v[160:175], v[100:103], v[68:75], v14
    s_add_u32 s79, s79, 221312
    s_cmp_lt_u32 s79, 7081984
    s_cbranch_scc1 L_slow_46
    s_nop 15
    s_branch L_norm_32
L_slowp_38:
    s_cmp_eq_u32 s65, 0
    s_cbranch_scc1 L_slowp_38_go
    v_min_u32 v114, -2, v114
    v_min_u32 v115, -2, v115
    v_min_u32 v116, -2, v116
    v_min_u32 v117, -2, v117
    v_min_u32 v118, -2, v118
    v_min_u32 v119, -2, v119
    v_min_u32 v120, -2, v120
    v_min_u32 v121, -2, v121
    v_min_u32 v122, -2, v122
    v_min_u32 v123, -2, v123
    v_min_u32 v124, -2, v124
    v_min_u32 v125, -2, v125
    s_branch L_normok_37
L_slowp_38_go:
    s_mov_b32 s65, 1
    s_waitcnt vmcnt(0) lgkmcnt(0)
    s_mov_b32 s80, 0x440000
    s_mov_b32 s81, 0x440000
    v_mov_b32 v104, 0x3f803f80
    v_cndmask_b32 v88, 0, v104, s[80:81]
    v_mov_b32 v89, v88
    v_mov_b64 v[90:91], v[88:89]
    v_mov_b64 v[92:93], v[88:89]
    v_mov_b64 v[94:95], v[88:89]
    v_mov_b64 v[96:97], v[88:89]
    v_mov_b64 v[98:99], v[88:89]
    v_mov_b64 v[100:101], v[88:89]
    v_mov_b64 v[102:103], v[88:89]
    v_mov_b32 v85, 0
    v_mov_b32 v176, 0
    v_mov_b32 v177, 0
    v_mov_b32 v178, 0
    v_mov_b32 v179, 0
    v_mov_b32 v180, 0
    v_mov_b32 v181, 0
    v_mov_b32 v182, 0
    v_mov_b32 v183, 0
    v_mov_b32 v184, 0
    v_mov_b32 v185, 0
    v_mov_b32 v186, 0
    v_mov_b32 v187, 0
    v_mov_b32 v188, 0
    v_mov_b32 v189, 0
    v_mov_b32 v190, 0
    v_mov_b32 v191, 0
    v_lshrrev_b32 v104, 5, v1
    v_lshl_add_u32 v105, v104, 8, v23
    v_mul_u32_u24 v106, 9216, v104
    v_and_b32 v104, 31, v1
    v_lshl_add_u32 v106, v104, 4, v106
    s_mul_i32 s63, s41, 288
    s_add_u32 s63, s63, 73728
    v_add_u32 v106, s63, v106
    v_add_u32 v107, 18432, v106
    v_add_u32 v108, 18432, v107
    v_add_u32 v109, 18432, v108
    v_mov_b32 v104, 0xff800000
    s_mov_b32 s79, 73728
L_slow_47:
    buffer_load_dwordx2 v[76:77], v22, s[20:23], s79 offen offset:0 sc1
    buffer_load_dwordx2 v[78:79], v22, s[20:23], s79 offen offset:512 sc1
    buffer_load_dwordx2 v[80:81], v22, s[20:23], s79 offen offset:256 sc1
    buffer_load_dwordx2 v[82:83], v22, s[20:23], s79 offen offset:768 sc1
    buffer_load_dword v84, v105, s[20:23], s79 offen sc1
    s_waitcnt vmcnt(0)
    v_mfma_f32_32x32x4_2b_bf16 v[44:75], v[84:85], v[12:13], 0
    s_nop 15
    s_nop 1
    v_mfma_f32_32x32x16_bf16 v[44:59], v[76:79], v[8:11], v[44:59]
    v_mfma_f32_32x32x16_bf16 v[60:75], v[80:83], v[8:11], v[60:75]
    s_nop 11
    v_max3_f32 v104, v104, v44, v45
    v_max3_f32 v104, v104, v46, v47
    v_max3_f32 v104, v104, v48, v49
    v_max3_f32 v104, v104, v50, v51
    v_max3_f32 v104, v104, v52, v53
    v_max3_f32 v104, v104, v54, v55
    v_max3_f32 v104, v104, v56, v57
    v_max3_f32 v104, v104, v58, v59
    v_max3_f32 v104, v104, v60, v61
    v_max3_f32 v104, v104, v62, v63
    v_max3_f32 v104, v104, v64, v65
    v_max3_f32 v104, v104, v66, v67
    v_max3_f32 v104, v104, v68, v69
    v_max3_f32 v104, v104, v70, v71
    v_max3_f32 v104, v104, v72, v73
    v_max3_f32 v104, v104, v74, v75
    s_add_u32 s79, s79, 221312
    s_cmp_lt_u32 s79, 7081984
    s_cbranch_scc1 L_slow_47
    v_mov_b32 v44, v104
    s_nop 1
    v_permlane32_swap_b32 v44, v104
    s_nop 1
    v_max_f32 v104, v104, v44
    s_mov_b32 s79, 73728
L_slow_48:
    buffer_load_dwordx2 v[76:77], v22, s[20:23], s79 offen offset:0 sc1
    buffer_load_dwordx2 v[78:79], v22, s[20:23], s79 offen offset:512 sc1
    buffer_load_dwordx2 v[80:81], v22, s[20:23], s79 offen offset:256 sc1
    buffer_load_dwordx2 v[82:83], v22, s[20:23], s79 offen offset:768 sc1
    buffer_load_dword v84, v105, s[20:23], s79 offen sc1
    s_mov_b64 exec, s[46:47]
    buffer_load_dwordx4 v[88:91], v106, s[20:23], s79 offen sc1
    buffer_load_dwordx4 v[92:95], v107, s[20:23], s79 offen sc1
    buffer_load_dwordx4 v[96:99], v108, s[20:23], s79 offen sc1
    buffer_load_dwordx4 v[100:103], v109, s[20:23], s79 offen sc1
    s_mov_b64 exec, -1
    s_waitcnt vmcnt(0)
    v_mfma_f32_32x32x4_2b_bf16 v[44:75], v[84:85], v[12:13], 0
    s_nop 15
    s_nop 1
    v_mfma_f32_32x32x16_bf16 v[44:59], v[76:79], v[8:11], v[44:59]
    v_mfma_f32_32x32x16_bf16 v[60:75], v[80:83], v[8:11], v[60:75]
    s_nop 11
    v_sub_f32 v44, v44, v104
    v_sub_f32 v45, v45, v104
    v_sub_f32 v46, v46, v104
    v_sub_f32 v47, v47, v104
    v_sub_f32 v48, v48, v104
    v_sub_f32 v49, v49, v104
    v_sub_f32 v50, v50, v104
    v_sub_f32 v51, v51, v104
    v_sub_f32 v52, v52, v104
    v_sub_f32 v53, v53, v104
    v_sub_f32 v54, v54, v104
    v_sub_f32 v55, v55, v104
    v_sub_f32 v56, v56, v104
    v_sub_f32 v57, v57, v104
    v_sub_f32 v58, v58, v104
    v_sub_f32 v59, v59, v104
    v_sub_f32 v60, v60, v104
    v_sub_f32 v61, v61, v104
    v_sub_f32 v62, v62, v104
    v_sub_f32 v63, v63, v104
    v_sub_f32 v64, v64, v104
    v_sub_f32 v65, v65, v104
    v_sub_f32 v66, v66, v104
    v_sub_f32 v67, v67, v104
    v_sub_f32 v68, v68, v104
    v_sub_f32 v69, v69, v104
    v_sub_f32 v70, v70, v104
    v_sub_f32 v71, v71, v104
    v_sub_f32 v72, v72, v104
    v_sub_f32 v73, v73, v104
    v_sub_f32 v74, v74, v104
    v_sub_f32 v75, v75, v104
    v_exp_f32 v44, v44
    v_exp_f32 v45, v45
    v_exp_f32 v46, v46
    v_exp_f32 v47, v47
    v_exp_f32 v48, v48
    v_exp_f32 v49, v49
    v_exp_f32 v50, v50
    v_exp_f32 v51, v51
    v_exp_f32 v52, v52
    v_exp_f32 v53, v53
    v_exp_f32 v54, v54
    v_exp_f32 v55, v55
    v_exp_f32 v56, v56
    v_exp_f32 v57, v57
    v_exp_f32 v58, v58
    v_exp_f32 v59, v59
    v_exp_f32 v60, v60
    v_exp_f32 v61, v61
    v_exp_f32 v62, v62
    v_exp_f32 v63, v63
    v_exp_f32 v64, v64
    v_exp_f32 v65, v65
    v_exp_f32 v66, v66
    v_exp_f32 v67, v67
    v_exp_f32 v68, v68
    v_exp_f32 v69, v69
    v_exp_f32 v70, v70
    v_exp_f32 v71, v71
    v_exp_f32 v72, v72
    v_exp_f32 v73, v73
    v_exp_f32 v74, v74
    v_exp_f32 v75, v75
    s_nop 1
    v_smfmac_f32_32x32x32_bf16 v[176:191], v[88:91], v[44:51], v14
    v_smfmac_f32_32x32x32_bf16 v[176:191], v[92:95], v[52:59], v14
    v_smfmac_f32_32x32x32_bf16 v[176:191], v[96:99], v[60:67], v14
    v_smfmac_f32_32x32x32_bf16 v[176:191], v[100:103], v[68:75], v14
    s_add_u32 s79, s79, 221312
    s_cmp_lt_u32 s79, 7081984
    s_cbranch_scc1 L_slow_48
    s_nop 15
    s_branch L_norm_36
.section .rodata,"a"
.p2align 6
.amdhsa_kernel standalone__mha_block__prompt_kernel
  .amdhsa_next_free_vgpr 256
  .amdhsa_next_free_sgpr 96
  .amdhsa_accum_offset 256
  .amdhsa_group_segment_fixed_size 0
  .amdhsa_kernarg_size 48
  .amdhsa_user_sgpr_count 2
  .amdhsa_user_sgpr_kernarg_segment_ptr 1
  .amdhsa_system_sgpr_workgroup_id_x 1
  .amdhsa_float_denorm_mode_32 3
.end_amdhsa_kernel
```
